```python
import torch

def _softmax(x, axis=-1):
    return torch.softmax(x, dim=axis)
def _gelu(x):
    return torch.nn.functional.gelu(x, approximate="tanh")
def _silu(x):
    return torch.nn.functional.silu(x)
def _sigmoid(x):
    return torch.sigmoid(x)
def _layernorm(x, axis=-1, eps=1e-5):
    m = x.mean(dim=axis, keepdim=True)
    v = x.var(dim=axis, keepdim=True, unbiased=False)
    return (x - m) / torch.sqrt(v + eps)
def _scatter_add(tgt, idx, src, axis=0):
    return tgt.clone().index_add_(axis, idx, src)
def _segment_sum(src, seg, n):
    out = torch.zeros((n,) + src.shape[1:], dtype=src.dtype)
    return out.index_add_(0, seg, src)
def _pad(x, pw):
    flat = tuple(v for pair in reversed(pw) for v in pair)
    return torch.nn.functional.pad(x, flat)

kernel_name = 'gated_mix__grouped_kv_mqa__glu_gated_geglu__prompt'

def setup_inputs():

    _w = (lambda a: (lambda t: t.to(torch.bfloat16) if t.is_floating_point() else t)(torch.as_tensor(a)))
    def _A_setup():
        B, S, D, H = 1, 2048, 512, 32
        Dh = D // H
        return {
            "x": _w((lambda *s: torch.randn(*s, dtype=torch.bfloat16) * 0.05)(B, S, D)),
            "wq": _w((lambda *s: torch.randn(*s, dtype=torch.bfloat16) * 0.8)(D, H * Dh)),
            "wk": _w((lambda *s: torch.randn(*s, dtype=torch.bfloat16) * 0.8)(D, Dh)),
            "wv": _w((lambda *s: torch.randn(*s, dtype=torch.bfloat16) * 0.05)(D, Dh)),
            "wo": _w((lambda *s: torch.randn(*s, dtype=torch.bfloat16) * 0.05)(H * Dh, D)),
        }
    _A_in = _A_setup()

    def _B_setup():
        B, S, Dm, Df = 1, 2048, 512, 1376
        return {
            "x": _w((lambda *s: torch.randn(*s, dtype=torch.bfloat16) * 0.05)(B, S, Dm)),
            "w_gate": _w((lambda *s: torch.randn(*s, dtype=torch.bfloat16) * 0.8)(Dm, Df) * (Dm ** -0.5)),
            "w_up": _w((lambda *s: torch.randn(*s, dtype=torch.bfloat16) * 0.8)(Dm, Df) * (Dm ** -0.5)),
            "w_down": _w((lambda *s: torch.randn(*s, dtype=torch.bfloat16) * 0.8)(Df, Dm) * (Df ** -0.5)),
        }
    _B_in = _B_setup()

    return {
        "A_x": _A_in["x"],
        "A_wq": _A_in["wq"],
        "A_wk": _A_in["wk"],
        "A_wv": _A_in["wv"],
        "A_wo": _A_in["wo"],
        "B_x": _B_in["x"],
        "B_w_gate": _B_in["w_gate"],
        "B_w_up": _B_in["w_up"],
        "B_w_down": _B_in["w_down"],
        "gate_w": _w((lambda *s: torch.randn(*s, dtype=torch.bfloat16) * 0.05)(512) * 16.0),
    }

def reference(A_x, A_wq, A_wk, A_wv, A_wo, B_x, B_w_gate, B_w_up, B_w_down, gate_w):
    def _A_ref(x, wq, wk, wv, wo):
        B, S, D = x.shape
        H = 32
        Dh = D // H
        q = (lambda x, *d: x.permute(*d))((x @ wq).reshape(B, S, H, Dh), 0, 2, 1, 3)
        k = x @ wk
        v = x @ wv
        scores = torch.einsum("bhqd,bkd->bhqk", q, k) * (Dh ** -0.5)
        p = _softmax(scores, axis=-1)
        o = torch.einsum("bhqk,bkd->bhqd", p, v)
        return (lambda x, *d: x.permute(*d))(o, 0, 2, 1, 3).reshape(B, S, H * Dh) @ wo

    def _B_ref(x, w_gate, w_up, w_down):
        g = torch.einsum("bsd,df->bsf", x, w_gate)
        u = torch.einsum("bsd,df->bsf", x, w_up)
        h = _gelu(g) * u
        return torch.einsum("bsf,fd->bsd", h, w_down)

    x = A_x
    g = _sigmoid((x * gate_w).sum(-1, keepdims=True))
    a = _A_ref(x, A_wq, A_wk, A_wv, A_wo)
    b = _B_ref(x, B_w_gate, B_w_up, B_w_down)
    return g * a + (1 - g) * b
```

```asm
; @launch grid=(256,1,1) block=(512,1,1) lds=163840
.amdgcn_target "amdgcn-amd-amdhsa--gfx950"
.text
.globl gated_mix__grouped_kv_mqa__glu_gated_geglu__prompt_kernel
.p2align 8
.type gated_mix__grouped_kv_mqa__glu_gated_geglu__prompt_kernel,@function
gated_mix__grouped_kv_mqa__glu_gated_geglu__prompt_kernel:
    s_cmp_ge_u32 s2, 256
    s_cbranch_scc1 LF_end
    s_load_dwordx16 s[4:19], s[0:1], 0
    s_load_dwordx8 s[20:27], s[0:1], 64
    s_load_dwordx2 s[28:29], s[0:1], 96
    s_getpc_b64 s[94:95]
LF_pc0:
    s_lshr_b32 s79, s2, 3
    s_lshl_b32 s79, s79, 11
    v_lshrrev_b32 v4, 5, v0
    v_lshlrev_b32 v4, 7, v4
    v_add_u32 v4, s79, v4
    v_min_u32 v4, LF_last-LF_pc0, v4
    s_mov_b32 exec_lo, 1
    s_mov_b32 exec_hi, 1
    global_load_dword v4, v4, s[94:95]
    s_mov_b64 exec, -1
    v_lshrrev_b32 v1, 6, v0
    v_and_b32 v2, 63, v0
    v_readfirstlane_b32 s72, v1
    v_lshlrev_b32 v3, 4, v2
    s_lshr_b32 s76, s2, 3
    s_and_b32 s73, s76, 3
    s_and_b32 s77, s2, 1
    s_lshl_b32 s77, s77, 2
    s_add_u32 s73, s73, s77
    s_and_b32 s74, s2, 6
    s_lshl_b32 s74, s74, 2
    s_lshr_b32 s76, s76, 2
    s_add_u32 s74, s74, s76
    v_lshrrev_b32 v6, 3, v2
    v_lshlrev_b32 v8, 10, v6
    v_lshlrev_b32 v6, 1, v6
    v_and_b32 v6, 4, v6
    v_xor_b32 v6, v6, v2
    v_and_b32 v6, 7, v6
    v_lshl_add_u32 v8, v6, 4, v8
    s_and_b32 s75, s72, 1
    s_lshl_b32 s86, s74, 1
    s_add_u32 s86, s86, s75
    s_lshr_b32 s30, s72, 1
    s_and_b32 s30, s30, 1
    s_lshr_b32 s31, s72, 2
    s_cmp_lg_u32 s72, 7
    s_cbranch_scc1 LF_not7
    s_setprio 3
    s_lshr_b32 s87, s73, 1
    s_lshl_b32 s76, s74, 16
    s_lshl_b32 s78, s87, 14
    s_add_u32 s78, s78, s76
    s_mul_i32 m0, s87, 16640
    s_and_b32 s79, s73, 1
    s_mov_b32 s88, 0
    s_waitcnt lgkmcnt(0)
    s_mov_b32 s32, s4
    s_and_b32 s33, s5, 0xffff
    s_mov_b32 s34, 0x200000
    s_mov_b32 s35, 0x20000
    s_sub_u32 s32, s32, 64
    s_subb_u32 s33, s33, 0
    s_mov_b32 s34, 0x200040
    s_add_u32 s78, s78, 64
    buffer_load_dwordx4 v3, s[32:35], s78 offen offset:0 lds
    s_sub_u32 s78, s78, 16
    buffer_load_dwordx4 v3, s[32:35], s78 offen offset:1040 lds
    s_sub_u32 s78, s78, 16
    buffer_load_dwordx4 v3, s[32:35], s78 offen offset:2080 lds
    s_sub_u32 s78, s78, 16
    buffer_load_dwordx4 v3, s[32:35], s78 offen offset:3120 lds
    s_add_u32 m0, m0, 4160
    s_add_u32 s78, s78, 4144
    buffer_load_dwordx4 v3, s[32:35], s78 offen offset:0 lds
    s_sub_u32 s78, s78, 16
    buffer_load_dwordx4 v3, s[32:35], s78 offen offset:1040 lds
    s_sub_u32 s78, s78, 16
    buffer_load_dwordx4 v3, s[32:35], s78 offen offset:2080 lds
    s_sub_u32 s78, s78, 16
    buffer_load_dwordx4 v3, s[32:35], s78 offen offset:3120 lds
    s_add_u32 m0, m0, 4160
    s_add_u32 s78, s78, 4144
    buffer_load_dwordx4 v3, s[32:35], s78 offen offset:0 lds
    s_sub_u32 s78, s78, 16
    buffer_load_dwordx4 v3, s[32:35], s78 offen offset:1040 lds
    s_sub_u32 s78, s78, 16
    buffer_load_dwordx4 v3, s[32:35], s78 offen offset:2080 lds
    s_sub_u32 s78, s78, 16
    buffer_load_dwordx4 v3, s[32:35], s78 offen offset:3120 lds
    s_add_u32 m0, m0, 4160
    s_add_u32 s78, s78, 4144
    buffer_load_dwordx4 v3, s[32:35], s78 offen offset:0 lds
    s_sub_u32 s78, s78, 16
    buffer_load_dwordx4 v3, s[32:35], s78 offen offset:1040 lds
    s_sub_u32 s78, s78, 16
    buffer_load_dwordx4 v3, s[32:35], s78 offen offset:2080 lds
    s_sub_u32 s78, s78, 16
    buffer_load_dwordx4 v3, s[32:35], s78 offen offset:3120 lds
    s_cmp_eq_u32 s79, 0
    s_cselect_b32 s40, s8, s10
    s_cselect_b32 s41, s9, s11
    s_and_b32 s41, s41, 0xffff
    s_mov_b32 s42, 0x4000
    s_mov_b32 s43, 0x20000
    s_mov_b32 m0, 0x22700
    s_mov_b32 s88, 0
LF_ldw7:
    buffer_load_dwordx4 v3, s[40:43], s88 offen offset:0 lds
    buffer_load_dwordx4 v3, s[40:43], s88 offen offset:1024 lds
    buffer_load_dwordx4 v3, s[40:43], s88 offen offset:2048 lds
    buffer_load_dwordx4 v3, s[40:43], s88 offen offset:3072 lds
    s_add_u32 m0, m0, 4096
    s_add_u32 s88, s88, 4096
    s_cmp_lg_u32 s88, 16384
    s_cbranch_scc1 LF_ldw7
    s_barrier
LF_not7:
    s_waitcnt lgkmcnt(0)
    v_mov_b32 v9, 0
    s_mov_b32 s52, s28
    s_and_b32 s53, s29, 0xffff
    s_mov_b32 s54, 0x1000000
    s_mov_b32 s55, 0x20000
    s_mov_b32 s68, s26
    s_and_b32 s69, s27, 0xffff
    s_mov_b32 s70, 0x100
    s_mov_b32 s71, 0x20000
    s_or_b32 s76, s2, s72
    s_cmp_lg_u32 s76, 0
    s_cbranch_scc1 LF_non
    s_memrealtime s[94:95]
    s_waitcnt lgkmcnt(0)
    s_mul_i32 s95, s95, 0x9e3779b1
    s_xor_b32 s94, s94, s95
    s_or_b32 s94, s94, 1
    v_mov_b32 v6, s94
    s_mov_b64 exec, 1
    buffer_store_dword v6, v9, s[68:71], 0 offen sc1
    s_mov_b64 exec, -1
    s_nop 1
LF_non:
    s_cmp_lg_u32 s72, 7
    s_cbranch_scc1 LF_not7b
    s_lshr_b32 s76, s73, 1
    s_lshl_b32 s77, s76, 4
    v_and_b32 v6, 15, v2
    v_add_u32 v7, s77, v6
    v_mul_u32_u24 v240, 1040, v7
    v_lshrrev_b32 v7, 4, v2
    v_lshl_add_u32 v240, v7, 4, v240
    v_lshlrev_b32 v241, 8, v7
    v_lshl_add_u32 v241, v6, 3, v241
    v_add_u32 v241, 0x22700, v241
    s_and_b32 s89, s73, 1
    s_cmp_eq_u32 s89, 0
    s_cselect_b32 s79, 9, 8
    s_cselect_b32 s87, 8, 9
    s_cselect_b32 s88, 0x0, 0x10000
    v_lshlrev_b32 v242, 4, v6
    v_lshrrev_b32 v6, 1, v7
    v_lshl_add_u32 v242, v6, 3, v242
    v_and_b32 v6, 1, v7
    v_lshlrev_b32 v6, s79, v6
    v_add_u32 v242, v242, v6
    s_and_b32 s77, s76, 1
    s_lshl_b32 s77, s77, s87
    s_add_u32 s88, s88, s77
    s_lshr_b32 s76, s76, 1
    s_lshl_b32 s77, s74, 1
    s_add_u32 s76, s76, s77
    s_lshl_b32 s76, s76, 10
    s_add_u32 s88, s88, s76
    s_waitcnt vmcnt(0)
    buffer_load_dword v10, v9, s[68:71], 0 offen sc1
    s_cmp_eq_u32 s89, 1
    s_cbranch_scc1 LF_vch
    ds_read_b128 v[208:211], v240 offset:0
    ds_read_b64_tr_b16 v[224:225], v241 offset:0
    ds_read_b64_tr_b16 v[226:227], v241 offset:128
    ds_read_b128 v[212:215], v240 offset:64
    ds_read_b64_tr_b16 v[228:229], v241 offset:1024
    ds_read_b64_tr_b16 v[230:231], v241 offset:1152
    ds_read_b128 v[216:219], v240 offset:128
    ds_read_b64_tr_b16 v[232:233], v241 offset:2048
    ds_read_b64_tr_b16 v[234:235], v241 offset:2176
    s_waitcnt lgkmcnt(6)
    v_mfma_f32_16x16x32_bf16 v[192:195], v[224:227], v[208:211], 0
    ds_read_b128 v[220:223], v240 offset:192
    ds_read_b64_tr_b16 v[236:237], v241 offset:3072
    ds_read_b64_tr_b16 v[238:239], v241 offset:3200
    s_waitcnt lgkmcnt(6)
    v_mfma_f32_16x16x32_bf16 v[192:195], v[228:231], v[212:215], v[192:195]
    ds_read_b128 v[208:211], v240 offset:256
    ds_read_b64_tr_b16 v[224:225], v241 offset:4096
    ds_read_b64_tr_b16 v[226:227], v241 offset:4224
    s_waitcnt lgkmcnt(6)
    v_mfma_f32_16x16x32_bf16 v[192:195], v[232:235], v[216:219], v[192:195]
    ds_read_b128 v[212:215], v240 offset:320
    ds_read_b64_tr_b16 v[228:229], v241 offset:5120
    ds_read_b64_tr_b16 v[230:231], v241 offset:5248
    s_waitcnt lgkmcnt(6)
    v_mfma_f32_16x16x32_bf16 v[192:195], v[236:239], v[220:223], v[192:195]
    ds_read_b128 v[216:219], v240 offset:384
    ds_read_b64_tr_b16 v[232:233], v241 offset:6144
    ds_read_b64_tr_b16 v[234:235], v241 offset:6272
    s_waitcnt lgkmcnt(6)
    v_mfma_f32_16x16x32_bf16 v[192:195], v[224:227], v[208:211], v[192:195]
    ds_read_b128 v[220:223], v240 offset:448
    ds_read_b64_tr_b16 v[236:237], v241 offset:7168
    ds_read_b64_tr_b16 v[238:239], v241 offset:7296
    s_waitcnt lgkmcnt(6)
    v_mfma_f32_16x16x32_bf16 v[192:195], v[228:231], v[212:215], v[192:195]
    ds_read_b128 v[208:211], v240 offset:512
    ds_read_b64_tr_b16 v[224:225], v241 offset:8192
    ds_read_b64_tr_b16 v[226:227], v241 offset:8320
    s_waitcnt lgkmcnt(6)
    v_mfma_f32_16x16x32_bf16 v[192:195], v[232:235], v[216:219], v[192:195]
    ds_read_b128 v[212:215], v240 offset:576
    ds_read_b64_tr_b16 v[228:229], v241 offset:9216
    ds_read_b64_tr_b16 v[230:231], v241 offset:9344
    s_waitcnt lgkmcnt(6)
    v_mfma_f32_16x16x32_bf16 v[192:195], v[236:239], v[220:223], v[192:195]
    ds_read_b128 v[216:219], v240 offset:640
    ds_read_b64_tr_b16 v[232:233], v241 offset:10240
    ds_read_b64_tr_b16 v[234:235], v241 offset:10368
    s_waitcnt lgkmcnt(6)
    v_mfma_f32_16x16x32_bf16 v[192:195], v[224:227], v[208:211], v[192:195]
    ds_read_b128 v[220:223], v240 offset:704
    ds_read_b64_tr_b16 v[236:237], v241 offset:11264
    ds_read_b64_tr_b16 v[238:239], v241 offset:11392
    s_waitcnt lgkmcnt(6)
    v_mfma_f32_16x16x32_bf16 v[192:195], v[228:231], v[212:215], v[192:195]
    ds_read_b128 v[208:211], v240 offset:768
    ds_read_b64_tr_b16 v[224:225], v241 offset:12288
    ds_read_b64_tr_b16 v[226:227], v241 offset:12416
    s_waitcnt lgkmcnt(6)
    v_mfma_f32_16x16x32_bf16 v[192:195], v[232:235], v[216:219], v[192:195]
    ds_read_b128 v[212:215], v240 offset:832
    ds_read_b64_tr_b16 v[228:229], v241 offset:13312
    ds_read_b64_tr_b16 v[230:231], v241 offset:13440
    s_waitcnt lgkmcnt(6)
    v_mfma_f32_16x16x32_bf16 v[192:195], v[236:239], v[220:223], v[192:195]
    ds_read_b128 v[216:219], v240 offset:896
    ds_read_b64_tr_b16 v[232:233], v241 offset:14336
    ds_read_b64_tr_b16 v[234:235], v241 offset:14464
    s_waitcnt lgkmcnt(6)
    v_mfma_f32_16x16x32_bf16 v[192:195], v[224:227], v[208:211], v[192:195]
    ds_read_b128 v[220:223], v240 offset:960
    ds_read_b64_tr_b16 v[236:237], v241 offset:15360
    ds_read_b64_tr_b16 v[238:239], v241 offset:15488
    s_waitcnt lgkmcnt(6)
    v_mfma_f32_16x16x32_bf16 v[192:195], v[228:231], v[212:215], v[192:195]
    s_waitcnt lgkmcnt(3)
    v_mfma_f32_16x16x32_bf16 v[192:195], v[232:235], v[216:219], v[192:195]
    s_waitcnt lgkmcnt(0)
    v_mfma_f32_16x16x32_bf16 v[192:195], v[236:239], v[220:223], v[192:195]
    s_mov_b32 s76, 0x3eb8aa3b
    s_nop 6
    v_mul_f32 v192, s76, v192
    v_mul_f32 v193, s76, v193
    v_mul_f32 v194, s76, v194
    v_mul_f32 v195, s76, v195
    s_nop 4
    s_branch LF_kvj
LF_vch:
    ds_read_b128 v[208:211], v240 offset:0
    ds_read_b64_tr_b16 v[224:225], v241 offset:0
    ds_read_b64_tr_b16 v[226:227], v241 offset:128
    ds_read_b128 v[212:215], v240 offset:64
    ds_read_b64_tr_b16 v[228:229], v241 offset:1024
    ds_read_b64_tr_b16 v[230:231], v241 offset:1152
    ds_read_b128 v[216:219], v240 offset:128
    ds_read_b64_tr_b16 v[232:233], v241 offset:2048
    ds_read_b64_tr_b16 v[234:235], v241 offset:2176
    s_waitcnt lgkmcnt(6)
    v_mfma_f32_16x16x32_bf16 v[192:195], v[208:211], v[224:227], 0
    ds_read_b128 v[220:223], v240 offset:192
    ds_read_b64_tr_b16 v[236:237], v241 offset:3072
    ds_read_b64_tr_b16 v[238:239], v241 offset:3200
    s_waitcnt lgkmcnt(6)
    v_mfma_f32_16x16x32_bf16 v[192:195], v[212:215], v[228:231], v[192:195]
    ds_read_b128 v[208:211], v240 offset:256
    ds_read_b64_tr_b16 v[224:225], v241 offset:4096
    ds_read_b64_tr_b16 v[226:227], v241 offset:4224
    s_waitcnt lgkmcnt(6)
    v_mfma_f32_16x16x32_bf16 v[192:195], v[216:219], v[232:235], v[192:195]
    ds_read_b128 v[212:215], v240 offset:320
    ds_read_b64_tr_b16 v[228:229], v241 offset:5120
    ds_read_b64_tr_b16 v[230:231], v241 offset:5248
    s_waitcnt lgkmcnt(6)
    v_mfma_f32_16x16x32_bf16 v[192:195], v[220:223], v[236:239], v[192:195]
    ds_read_b128 v[216:219], v240 offset:384
    ds_read_b64_tr_b16 v[232:233], v241 offset:6144
    ds_read_b64_tr_b16 v[234:235], v241 offset:6272
    s_waitcnt lgkmcnt(6)
    v_mfma_f32_16x16x32_bf16 v[192:195], v[208:211], v[224:227], v[192:195]
    ds_read_b128 v[220:223], v240 offset:448
    ds_read_b64_tr_b16 v[236:237], v241 offset:7168
    ds_read_b64_tr_b16 v[238:239], v241 offset:7296
    s_waitcnt lgkmcnt(6)
    v_mfma_f32_16x16x32_bf16 v[192:195], v[212:215], v[228:231], v[192:195]
    ds_read_b128 v[208:211], v240 offset:512
    ds_read_b64_tr_b16 v[224:225], v241 offset:8192
    ds_read_b64_tr_b16 v[226:227], v241 offset:8320
    s_waitcnt lgkmcnt(6)
    v_mfma_f32_16x16x32_bf16 v[192:195], v[216:219], v[232:235], v[192:195]
    ds_read_b128 v[212:215], v240 offset:576
    ds_read_b64_tr_b16 v[228:229], v241 offset:9216
    ds_read_b64_tr_b16 v[230:231], v241 offset:9344
    s_waitcnt lgkmcnt(6)
    v_mfma_f32_16x16x32_bf16 v[192:195], v[220:223], v[236:239], v[192:195]
    ds_read_b128 v[216:219], v240 offset:640
    ds_read_b64_tr_b16 v[232:233], v241 offset:10240
    ds_read_b64_tr_b16 v[234:235], v241 offset:10368
    s_waitcnt lgkmcnt(6)
    v_mfma_f32_16x16x32_bf16 v[192:195], v[208:211], v[224:227], v[192:195]
    ds_read_b128 v[220:223], v240 offset:704
    ds_read_b64_tr_b16 v[236:237], v241 offset:11264
    ds_read_b64_tr_b16 v[238:239], v241 offset:11392
    s_waitcnt lgkmcnt(6)
    v_mfma_f32_16x16x32_bf16 v[192:195], v[212:215], v[228:231], v[192:195]
    ds_read_b128 v[208:211], v240 offset:768
    ds_read_b64_tr_b16 v[224:225], v241 offset:12288
    ds_read_b64_tr_b16 v[226:227], v241 offset:12416
    s_waitcnt lgkmcnt(6)
    v_mfma_f32_16x16x32_bf16 v[192:195], v[216:219], v[232:235], v[192:195]
    ds_read_b128 v[212:215], v240 offset:832
    ds_read_b64_tr_b16 v[228:229], v241 offset:13312
    ds_read_b64_tr_b16 v[230:231], v241 offset:13440
    s_waitcnt lgkmcnt(6)
    v_mfma_f32_16x16x32_bf16 v[192:195], v[220:223], v[236:239], v[192:195]
    ds_read_b128 v[216:219], v240 offset:896
    ds_read_b64_tr_b16 v[232:233], v241 offset:14336
    ds_read_b64_tr_b16 v[234:235], v241 offset:14464
    s_waitcnt lgkmcnt(6)
    v_mfma_f32_16x16x32_bf16 v[192:195], v[208:211], v[224:227], v[192:195]
    ds_read_b128 v[220:223], v240 offset:960
    ds_read_b64_tr_b16 v[236:237], v241 offset:15360
    ds_read_b64_tr_b16 v[238:239], v241 offset:15488
    s_waitcnt lgkmcnt(6)
    v_mfma_f32_16x16x32_bf16 v[192:195], v[212:215], v[228:231], v[192:195]
    s_waitcnt lgkmcnt(3)
    v_mfma_f32_16x16x32_bf16 v[192:195], v[216:219], v[232:235], v[192:195]
    s_waitcnt lgkmcnt(0)
    v_mfma_f32_16x16x32_bf16 v[192:195], v[220:223], v[236:239], v[192:195]
    s_nop 7
LF_kvj:
    v_cvt_pk_bf16_f32 v196, v192, v193
    v_cvt_pk_bf16_f32 v197, v194, v195
    buffer_store_dwordx2 v[196:197], v242, s[52:55], s88 offen sc1
    s_lshl_b32 s76, s74, 3
    s_add_u32 s76, s76, s73
    s_lshl_b32 s76, s76, 2
    s_add_u32 s76, s76, 0x24000
    s_waitcnt vmcnt(0)
    v_readfirstlane_b32 s93, v10
    s_nop 0
    s_cmp_lg_u32 s93, 0
    s_cbranch_scc1 LR0
    s_mov_b32 s90, 0
LS0_l:
    s_sleep 2
    buffer_load_dword v10, v9, s[68:71], 0 offen sc1
    s_waitcnt vmcnt(0)
    v_readfirstlane_b32 s93, v10
    s_add_u32 s90, s90, 1
    s_cmp_ge_u32 s90, 0x400000
    s_cbranch_scc1 LR0
    s_cmp_eq_u32 s93, 0
    s_cbranch_scc1 LS0_l
LR0:
    s_nop 0
    v_mov_b32 v6, s93
    s_mov_b64 exec, 1
    buffer_store_dword v6, v9, s[52:55], s76 offen sc1
    s_mov_b64 exec, -1
    s_barrier
    s_barrier
    s_branch LF_light
LF_not7b:
    s_cmp_lg_u32 s31, 0
    s_cbranch_scc1 LF_l0
    v_and_b32 v6, 31, v2
    s_lshl_b32 s76, s75, 5
    v_add_u32 v6, s76, v6
    v_mul_u32_u24 v14, 1040, v6
    v_lshrrev_b32 v6, 5, v2
    v_lshl_add_u32 v14, v6, 4, v14
    s_cmp_eq_u32 s75, 0
    s_cselect_b32 s44, s16, s18
    s_cselect_b32 s45, s17, s19
    s_and_b32 s45, s45, 0xffff
    s_mov_b32 s46, 0x158000
    s_mov_b32 s47, 0x20000
    v_lshrrev_b32 v6, 5, v2
    v_mul_u32_u24 v240, 8, v6
    v_bfe_u32 v6, v2, 2, 2
    v_add_u32 v240, v240, v6
    v_lshlrev_b32 v240, 7, v240
    v_lshlrev_b32 v6, 1, v6
    v_and_b32 v6, 4, v6
    v_bfe_u32 v7, v2, 4, 1
    v_lshlrev_b32 v7, 1, v7
    v_xor_b32 v6, v6, v7
    v_bfe_u32 v7, v2, 1, 1
    v_xor_b32 v6, v6, v7
    s_lshl_b32 s76, s30, 2
    v_xor_b32 v6, s76, v6
    v_lshl_add_u32 v240, v6, 4, v240
    v_and_b32 v6, 1, v2
    v_lshl_add_u32 v240, v6, 3, v240
    v_add_u32 v240, 0x10400, v240
    v_bfe_u32 v6, v2, 4, 1
    v_lshrrev_b32 v7, 5, v2
    v_lshl_add_u32 v6, v7, 7, v6
    v_mul_u32_u24 v241, 2752, v6
    v_and_b32 v6, 15, v2
    v_lshl_add_u32 v241, v6, 7, v241
    v_cmp_gt_u32 vcc, 12, v6
    v_mov_b32 v7, 0x40000000
    s_nop 0
    v_cndmask_b32 v241, v7, v241, vcc
    s_lshr_b32 s76, s2, 3
    s_lshl_b32 s76, s76, 1
    s_add_u32 s76, s76, s30
    s_mul_i32 s76, s76, 5504
    s_and_b32 s77, s2, 1
    s_mul_i32 s77, s77, 1408
    s_add_u32 s19, s76, s77
    s_barrier
    s_lshr_b32 s87, s73, 1
    s_lshl_b32 s87, s87, 4
    s_mul_i32 s77, s72, 12
    s_add_u32 s87, s87, s77
    s_add_u32 s87, s87, 16
    s_lshl_b32 s76, s74, 16
    s_and_b32 s89, s73, 3
    s_mul_i32 s89, s89, 3
    s_mov_b32 s88, 12
    s_mov_b32 s32, s4
    s_and_b32 s33, s5, 0xffff
    s_mov_b32 s34, 0x200000
    s_mov_b32 s35, 0x20000
LF_ldx1:
    s_add_u32 s77, s89, s87
    s_and_b32 s77, s77, 63
    s_mul_i32 m0, s77, 1040
    s_lshl_b32 s78, s77, 10
    s_add_u32 s78, s78, s76
    s_add_u32 s89, s89, 1
    s_cmp_eq_u32 s89, 12
    s_cselect_b32 s89, 0, s89
    buffer_load_dwordx4 v3, s[32:35], s78 offen lds
    s_sub_u32 s88, s88, 1
    s_cmp_lg_u32 s88, 0
    s_cbranch_scc1 LF_ldx1
    s_waitcnt vmcnt(0)
    s_barrier
    ds_read_b128 v[136:139], v14 offset:0
    ds_read_b64_tr_b16 v[168:169], v240 offset:0
    ds_read_b64_tr_b16 v[170:171], v240 offset:512
    ds_read_b128 v[140:143], v14 offset:32
    ds_read_b64_tr_b16 v[172:173], v240 offset:2048
    ds_read_b64_tr_b16 v[174:175], v240 offset:2560
    ds_read_b128 v[144:147], v14 offset:64
    ds_read_b64_tr_b16 v[176:177], v240 offset:4096
    ds_read_b64_tr_b16 v[178:179], v240 offset:4608
    ds_read_b128 v[148:151], v14 offset:96
    ds_read_b64_tr_b16 v[180:181], v240 offset:6144
    ds_read_b64_tr_b16 v[182:183], v240 offset:6656
    ds_read_b128 v[152:155], v14 offset:128
    ds_read_b64_tr_b16 v[184:185], v240 offset:8192
    ds_read_b64_tr_b16 v[186:187], v240 offset:8704
    s_waitcnt lgkmcnt(8)
    v_mfma_f32_32x32x16_bf16 v[104:119], v[168:171], v[136:139], 0
    ds_read_b128 v[156:159], v14 offset:160
    ds_read_b64_tr_b16 v[188:189], v240 offset:10240
    ds_read_b64_tr_b16 v[190:191], v240 offset:10752
    s_lshl_b32 s77, s31, 12
    s_add_u32 s77, s77, 0x22700
    v_add_u32 v11, s77, v3
    v_mfma_f32_32x32x16_bf16 v[104:119], v[172:175], v[140:143], v[104:119]
    ds_read_b128 v[136:139], v14 offset:192
    ds_read_b64_tr_b16 v[168:169], v240 offset:12288
    ds_read_b64_tr_b16 v[170:171], v240 offset:12800
    v_lshrrev_b32 v6, 5, v2
    v_lshlrev_b32 v6, 8, v6
    v_and_b32 v7, 15, v2
    s_waitcnt lgkmcnt(3)
    v_mfma_f32_32x32x16_bf16 v[104:119], v[176:179], v[144:147], v[104:119]
    ds_read_b128 v[140:143], v14 offset:224
    ds_read_b64_tr_b16 v[172:173], v240 offset:14336
    ds_read_b64_tr_b16 v[174:175], v240 offset:14848
    v_lshl_add_u32 v6, v7, 4, v6
    v_and_b32 v7, 16, v2
    v_cmp_eq_u32 vcc, 0, v7
    v_mfma_f32_32x32x16_bf16 v[104:119], v[180:183], v[148:151], v[104:119]
    ds_read_b128 v[144:147], v14 offset:256
    ds_read_b64_tr_b16 v[176:177], v240 offset:16384
    ds_read_b64_tr_b16 v[178:179], v240 offset:16896
    s_add_u32 s77, s77, 2048
    v_mov_b32 v7, s77
    v_add_u32 v7, 0, v7
    v_mfma_f32_32x32x16_bf16 v[104:119], v[184:187], v[152:155], v[104:119]
    ds_read_b128 v[148:151], v14 offset:288
    ds_read_b64_tr_b16 v[180:181], v240 offset:18432
    ds_read_b64_tr_b16 v[182:183], v240 offset:18944
    v_mov_b32 v12, 0x26700
    v_cndmask_b32 v12, v7, v12, vcc
    v_add_u32 v12, v12, v6
    v_mfma_f32_32x32x16_bf16 v[104:119], v[188:191], v[156:159], v[104:119]
    ds_read_b128 v[152:155], v14 offset:320
    ds_read_b64_tr_b16 v[184:185], v240 offset:20480
    ds_read_b64_tr_b16 v[186:187], v240 offset:20992
    v_mov_b32 v7, s77
    v_add_u32 v7, 8192, v7
    v_mov_b32 v13, 0x26700
    s_waitcnt lgkmcnt(3)
    v_mfma_f32_32x32x16_bf16 v[104:119], v[168:171], v[136:139], v[104:119]
    ds_read_b128 v[156:159], v14 offset:352
    ds_read_b64_tr_b16 v[188:189], v240 offset:22528
    ds_read_b64_tr_b16 v[190:191], v240 offset:23040
    v_cndmask_b32 v13, v7, v13, vcc
    v_add_u32 v13, v13, v6
    s_lshl_b32 s91, s31, 15
    v_mfma_f32_32x32x16_bf16 v[104:119], v[172:175], v[140:143], v[104:119]
    s_barrier
    ds_read_b128 v[136:139], v14 offset:384
    ds_read_b64_tr_b16 v[168:169], v240 offset:24832
    ds_read_b64_tr_b16 v[170:171], v240 offset:25344
    s_lshl_b32 s77, s30, 16
    s_add_u32 s91, s91, s77
    s_lshl_b32 s77, s75, 10
    v_mfma_f32_32x32x16_bf16 v[104:119], v[176:179], v[144:147], v[104:119]
    ds_read_b128 v[140:143], v14 offset:416
    ds_read_b64_tr_b16 v[172:173], v240 offset:26880
    ds_read_b64_tr_b16 v[174:175], v240 offset:27392
    s_add_u32 s91, s91, s77
    s_lshl_b32 s92, s72, 10
    s_add_u32 s92, s92, 0x22700
    v_mfma_f32_32x32x16_bf16 v[104:119], v[180:183], v[148:151], v[104:119]
    ds_read_b128 v[144:147], v14 offset:448
    ds_read_b64_tr_b16 v[176:177], v240 offset:28928
    ds_read_b64_tr_b16 v[178:179], v240 offset:29440
    s_and_b32 s76, s72, 3
    s_lshl_b32 s77, s76, 11
    s_add_u32 s77, s77, 0x24700
    s_waitcnt lgkmcnt(3)
    v_mfma_f32_32x32x16_bf16 v[104:119], v[184:187], v[152:155], v[104:119]
    ds_read_b128 v[148:151], v14 offset:480
    ds_read_b64_tr_b16 v[180:181], v240 offset:30976
    ds_read_b64_tr_b16 v[182:183], v240 offset:31488
    v_add_u32 v15, s77, v3
    s_mul_i32 s76, s75, 33280
    v_subrev_u32 v244, s76, v14
    v_mfma_f32_32x32x16_bf16 v[104:119], v[188:191], v[156:159], v[104:119]
    s_barrier
    ds_read_b128 v[152:155], v14 offset:512
    ds_read_b64_tr_b16 v[184:185], v240 offset:33024
    ds_read_b64_tr_b16 v[186:187], v240 offset:33536
    s_lshl_b32 s87, s72, 1
    s_lshr_b32 s76, s87, 1
    s_mul_i32 s76, s76, 3
    v_mfma_f32_32x32x16_bf16 v[104:119], v[168:171], v[136:139], v[104:119]
    ds_read_b128 v[156:159], v14 offset:544
    ds_read_b64_tr_b16 v[188:189], v240 offset:35072
    ds_read_b64_tr_b16 v[190:191], v240 offset:35584
    v_lshrrev_b32 v6, 5, v2
    v_lshlrev_b32 v6, 3, v6
    v_bfe_u32 v7, v2, 2, 2
    v_mfma_f32_32x32x16_bf16 v[104:119], v[172:175], v[140:143], v[104:119]
    ds_read_b128 v[136:139], v14 offset:576
    ds_read_b64_tr_b16 v[168:169], v240 offset:37120
    ds_read_b64_tr_b16 v[170:171], v240 offset:37632
    v_add_u32 v6, v6, v7
    v_mul_u32_u24 v245, 384, v6
    v_bfe_u32 v6, v2, 4, 1
    s_waitcnt lgkmcnt(3)
    v_mfma_f32_32x32x16_bf16 v[104:119], v[176:179], v[144:147], v[104:119]
    ds_read_b128 v[140:143], v14 offset:608
    ds_read_b64_tr_b16 v[172:173], v240 offset:39168
    ds_read_b64_tr_b16 v[174:175], v240 offset:39680
    v_mul_u32_u24 v6, 12352, v6
    v_add_u32 v245, v245, v6
    v_and_b32 v6, 3, v2
    v_mfma_f32_32x32x16_bf16 v[104:119], v[180:183], v[148:151], v[104:119]
    ds_read_b128 v[144:147], v14 offset:640
    ds_read_b64_tr_b16 v[176:177], v240 offset:41216
    ds_read_b64_tr_b16 v[178:179], v240 offset:41728
    v_lshl_add_u32 v245, v6, 3, v245
    v_add_u32 v245, 0x10400, v245
    v_bfe_u32 v7, v2, 3, 1
    v_mfma_f32_32x32x16_bf16 v[104:119], v[184:187], v[152:155], v[104:119]
    ds_read_b128 v[148:151], v14 offset:672
    ds_read_b64_tr_b16 v[180:181], v240 offset:43264
    ds_read_b64_tr_b16 v[182:183], v240 offset:43776
    s_add_u32 s77, s76, 0
    v_xor_b32 v6, s77, v7
    v_lshl_add_u32 v246, v6, 5, v245
    v_mfma_f32_32x32x16_bf16 v[104:119], v[188:191], v[156:159], v[104:119]
    ds_read_b128 v[152:155], v14 offset:704
    ds_read_b64_tr_b16 v[184:185], v240 offset:45312
    ds_read_b64_tr_b16 v[186:187], v240 offset:45824
    s_add_u32 s77, s76, 1
    v_xor_b32 v6, s77, v7
    v_lshl_add_u32 v247, v6, 5, v245
    s_waitcnt lgkmcnt(3)
    v_mfma_f32_32x32x16_bf16 v[104:119], v[168:171], v[136:139], v[104:119]
    ds_read_b128 v[156:159], v14 offset:736
    ds_read_b64_tr_b16 v[188:189], v240 offset:47360
    ds_read_b64_tr_b16 v[190:191], v240 offset:47872
    s_add_u32 s77, s76, 2
    v_xor_b32 v6, s77, v7
    v_lshl_add_u32 v248, v6, 5, v245
    v_mfma_f32_32x32x16_bf16 v[104:119], v[172:175], v[140:143], v[104:119]
    s_barrier
    ds_read_b128 v[136:139], v14 offset:768
    ds_read_b64_tr_b16 v[168:169], v240 offset:49664
    ds_read_b64_tr_b16 v[170:171], v240 offset:50176
    s_lshl_b32 s76, s30, 1
    s_add_u32 s76, s76, s31
    s_lshl_b32 s77, s73, 2
    v_mfma_f32_32x32x16_bf16 v[104:119], v[176:179], v[144:147], v[104:119]
    ds_read_b128 v[140:143], v14 offset:800
    ds_read_b64_tr_b16 v[172:173], v240 offset:51712
    ds_read_b64_tr_b16 v[174:175], v240 offset:52224
    s_add_u32 s76, s76, s77
    s_mul_i32 s77, s86, 118
    s_add_u32 s76, s76, s77
    v_mfma_f32_32x32x16_bf16 v[104:119], v[180:183], v[148:151], v[104:119]
    ds_read_b128 v[144:147], v14 offset:832
    ds_read_b64_tr_b16 v[176:177], v240 offset:53760
    ds_read_b64_tr_b16 v[178:179], v240 offset:54272
    s_lshl_b32 s76, s76, 10
    s_add_u32 s9, s76, 0x415800
    s_lshr_b32 s76, s72, 1
    s_waitcnt lgkmcnt(3)
    v_mfma_f32_32x32x16_bf16 v[104:119], v[184:187], v[152:155], v[104:119]
    ds_read_b128 v[148:151], v14 offset:864
    ds_read_b64_tr_b16 v[180:181], v240 offset:55808
    ds_read_b64_tr_b16 v[182:183], v240 offset:56320
    s_lshl_b32 s76, s76, 3
    s_add_u32 s76, s76, s77
    s_lshl_b32 s76, s76, 10
    v_mfma_f32_32x32x16_bf16 v[104:119], v[188:191], v[156:159], v[104:119]
    s_barrier
    ds_read_b128 v[152:155], v14 offset:896
    ds_read_b64_tr_b16 v[184:185], v240 offset:57856
    ds_read_b64_tr_b16 v[186:187], v240 offset:58368
    s_add_u32 s10, s76, 0x415800
    v_mfma_f32_32x32x16_bf16 v[104:119], v[168:171], v[136:139], v[104:119]
    ds_read_b128 v[156:159], v14 offset:928
    ds_read_b64_tr_b16 v[188:189], v240 offset:59904
    ds_read_b64_tr_b16 v[190:191], v240 offset:60416
    v_mfma_f32_32x32x16_bf16 v[104:119], v[172:175], v[140:143], v[104:119]
    ds_read_b128 v[136:139], v14 offset:960
    ds_read_b64_tr_b16 v[168:169], v240 offset:61952
    ds_read_b64_tr_b16 v[170:171], v240 offset:62464
    s_waitcnt lgkmcnt(6)
    v_mfma_f32_32x32x16_bf16 v[104:119], v[176:179], v[144:147], v[104:119]
    ds_read_b128 v[140:143], v14 offset:992
    ds_read_b64_tr_b16 v[172:173], v240 offset:64000
    ds_read_b64_tr_b16 v[174:175], v240 offset:64512
    v_mfma_f32_32x32x16_bf16 v[104:119], v[180:183], v[148:151], v[104:119]
    v_mfma_f32_32x32x16_bf16 v[104:119], v[184:187], v[152:155], v[104:119]
    s_waitcnt lgkmcnt(4)
    v_mfma_f32_32x32x16_bf16 v[104:119], v[188:191], v[156:159], v[104:119]
    s_waitcnt lgkmcnt(3)
    v_mfma_f32_32x32x16_bf16 v[104:119], v[168:171], v[136:139], v[104:119]
    s_waitcnt lgkmcnt(0)
    v_mfma_f32_32x32x16_bf16 v[104:119], v[172:175], v[140:143], v[104:119]
    s_nop 11
    v_cvt_pk_bf16_f32 v92, v104, v105
    v_cvt_pk_bf16_f32 v93, v106, v107
    v_cvt_pk_bf16_f32 v94, v108, v109
    v_cvt_pk_bf16_f32 v95, v110, v111
    v_cvt_pk_bf16_f32 v96, v112, v113
    v_cvt_pk_bf16_f32 v97, v114, v115
    v_cvt_pk_bf16_f32 v98, v116, v117
    v_cvt_pk_bf16_f32 v99, v118, v119
    ds_write_b128 v15, v[92:95]
    ds_write_b128 v15, v[96:99] offset:1024
    s_waitcnt lgkmcnt(0)
    s_barrier
    ds_read_b128 v[200:203], v244 offset:0
    ds_read_b64_tr_b16 v[216:217], v246 offset:0
    ds_read_b64_tr_b16 v[218:219], v246 offset:1536
    ds_read_b128 v[204:207], v244 offset:33280
    ds_read_b64_tr_b16 v[220:221], v247 offset:0
    ds_read_b64_tr_b16 v[222:223], v247 offset:1536
    ds_read_b64_tr_b16 v[224:225], v248 offset:0
    ds_read_b64_tr_b16 v[226:227], v248 offset:1536
    s_mov_b32 s88, 0x24000
    buffer_load_dword v10, v9, s[68:71], 0 offen sc1
    buffer_load_dwordx4 v[100:103], v3, s[52:55], s88 offen sc1
    s_waitcnt lgkmcnt(5)
    v_mfma_f32_32x32x16_bf16 v[104:119], v[216:219], v[200:203], 0
    ds_read_b128 v[208:211], v244 offset:32
    ds_read_b64_tr_b16 v[228:229], v246 offset:6144
    s_waitcnt lgkmcnt(3)
    v_mfma_f32_32x32x16_bf16 v[120:135], v[216:219], v[204:207], 0
    ds_read_b64_tr_b16 v[230:231], v246 offset:7680
    ds_read_b128 v[212:215], v244 offset:33312
    v_mfma_f32_32x32x16_bf16 v[136:151], v[220:223], v[200:203], 0
    ds_read_b64_tr_b16 v[232:233], v247 offset:6144
    ds_read_b64_tr_b16 v[234:235], v247 offset:7680
    v_mfma_f32_32x32x16_bf16 v[152:167], v[220:223], v[204:207], 0
    ds_read_b64_tr_b16 v[236:237], v248 offset:6144
    ds_read_b64_tr_b16 v[238:239], v248 offset:7680
    s_waitcnt lgkmcnt(6)
    v_mfma_f32_32x32x16_bf16 v[168:183], v[224:227], v[200:203], 0
    v_mfma_f32_32x32x16_bf16 v[184:199], v[224:227], v[204:207], 0
    s_waitcnt vmcnt(1)
    v_readfirstlane_b32 s93, v10
    s_nop 0
    s_cmp_lg_u32 s93, 0
    s_cbranch_scc1 LR1
    s_mov_b32 s90, 0
LS1_l:
    s_sleep 2
    buffer_load_dword v10, v9, s[68:71], 0 offen sc1
    s_waitcnt vmcnt(0)
    v_readfirstlane_b32 s93, v10
    s_add_u32 s90, s90, 1
    s_cmp_ge_u32 s90, 0x400000
    s_cbranch_scc1 LR1
    s_cmp_eq_u32 s93, 0
    s_cbranch_scc1 LS1_l
LR1:
    s_nop 0
    s_waitcnt vmcnt(0)
    v_xor_b32 v6, s93, v100
    v_xor_b32 v101, s93, v101
    v_or_b32 v6, v6, v101
    v_xor_b32 v102, s93, v102
    v_or_b32 v6, v6, v102
    v_xor_b32 v103, s93, v103
    v_or_b32 v6, v6, v103
    v_cmp_ne_u32 vcc, 0, v6
    s_cbranch_vccz LR2
    s_mov_b32 s90, 0
LS2_l:
    s_sleep 6
    buffer_load_dwordx4 v[100:103], v3, s[52:55], s88 offen sc1
    s_waitcnt vmcnt(0)
    v_xor_b32 v6, s93, v100
    v_xor_b32 v101, s93, v101
    v_or_b32 v6, v6, v101
    v_xor_b32 v102, s93, v102
    v_or_b32 v6, v6, v102
    v_xor_b32 v103, s93, v103
    v_or_b32 v6, v6, v103
    v_cmp_ne_u32 vcc, 0, v6
    s_add_u32 s90, s90, 1
    s_cmp_ge_u32 s90, 0x400000
    s_cbranch_scc1 LR2
    s_cbranch_vccnz LS2_l
LR2:
    s_mov_b32 m0, s92
    s_add_u32 s78, s91, 0
    buffer_load_dwordx4 v3, s[52:55], s78 offen sc1 lds
    s_add_u32 m0, s92, 0x1000
    s_add_u32 s78, s78, 32768
    buffer_load_dwordx4 v3, s[52:55], s78 offen sc1 lds
    s_waitcnt lgkmcnt(0)
    s_barrier
    v_mfma_f32_32x32x16_bf16 v[104:119], v[228:231], v[208:211], v[104:119]
    ds_read_b128 v[200:203], v244 offset:64
    ds_read_b64_tr_b16 v[216:217], v246 offset:24832
    v_mfma_f32_32x32x16_bf16 v[120:135], v[228:231], v[212:215], v[120:135]
    ds_read_b64_tr_b16 v[218:219], v246 offset:26368
    ds_read_b128 v[204:207], v244 offset:33344
    v_mfma_f32_32x32x16_bf16 v[136:151], v[232:235], v[208:211], v[136:151]
    ds_read_b64_tr_b16 v[220:221], v247 offset:24832
    ds_read_b64_tr_b16 v[222:223], v247 offset:26368
    v_mfma_f32_32x32x16_bf16 v[152:167], v[232:235], v[212:215], v[152:167]
    ds_read_b64_tr_b16 v[224:225], v248 offset:24832
    ds_read_b64_tr_b16 v[226:227], v248 offset:26368
    v_mfma_f32_32x32x16_bf16 v[168:183], v[236:239], v[208:211], v[168:183]
    v_mfma_f32_32x32x16_bf16 v[184:199], v[236:239], v[212:215], v[184:199]
    s_waitcnt lgkmcnt(4)
    v_mfma_f32_32x32x16_bf16 v[104:119], v[216:219], v[200:203], v[104:119]
    ds_read_b128 v[208:211], v244 offset:96
    ds_read_b64_tr_b16 v[228:229], v246 offset:30976
    v_mfma_f32_32x32x16_bf16 v[120:135], v[216:219], v[204:207], v[120:135]
    ds_read_b64_tr_b16 v[230:231], v246 offset:32512
    ds_read_b128 v[212:215], v244 offset:33376
    s_waitcnt lgkmcnt(4)
    v_mfma_f32_32x32x16_bf16 v[136:151], v[220:223], v[200:203], v[136:151]
    ds_read_b64_tr_b16 v[232:233], v247 offset:30976
    ds_read_b64_tr_b16 v[234:235], v247 offset:32512
    v_mfma_f32_32x32x16_bf16 v[152:167], v[220:223], v[204:207], v[152:167]
    ds_read_b64_tr_b16 v[236:237], v248 offset:30976
    ds_read_b64_tr_b16 v[238:239], v248 offset:32512
    v_mfma_f32_32x32x16_bf16 v[168:183], v[224:227], v[200:203], v[168:183]
    v_mfma_f32_32x32x16_bf16 v[184:199], v[224:227], v[204:207], v[184:199]
    s_waitcnt vmcnt(0)
    s_waitcnt lgkmcnt(0)
    s_barrier
    s_mov_b32 s28, 0xffff0000
    s_mov_b32 s29, 0xffff0000
    ds_read_b128 v[80:83], v11 offset:0
    ds_read_b128 v[84:87], v12 offset:0
    s_waitcnt lgkmcnt(1)
    v_mfma_f32_32x32x16_bf16 v[16:31], v[80:83], v[92:95], 0
    s_nop 11
    v_exp_f32 v16, v16
    v_exp_f32 v17, v17
    ds_read_b128 v[88:91], v12 offset:512
    s_setprio 1
    v_exp_f32 v18, v18
    v_exp_f32 v19, v19
    v_mfma_f32_32x32x16_bf16 v[104:119], v[228:231], v[208:211], v[104:119]
    ds_read_b128 v[200:203], v244 offset:128
    ds_read_b64_tr_b16 v[216:217], v246 offset:49664
    v_exp_f32 v20, v20
    v_exp_f32 v21, v21
    v_mfma_f32_32x32x16_bf16 v[120:135], v[228:231], v[212:215], v[120:135]
    ds_read_b64_tr_b16 v[218:219], v246 offset:51200
    ds_read_b128 v[204:207], v244 offset:33408
    v_exp_f32 v22, v22
    v_exp_f32 v23, v23
    v_mfma_f32_32x32x16_bf16 v[32:47], v[80:83], v[96:99], 0
    s_mov_b32 s56, s24
    s_and_b32 s57, s25, 0xffff
    s_mov_b32 s58, 0x200000
    s_mov_b32 s59, 0x20000
    s_mov_b32 s60, s12
    s_and_b32 s61, s13, 0xffff
    s_mov_b32 s62, 0x80000
    s_mov_b32 s63, 0x20000
    v_cvt_pk_bf16_f32 v16, v16, v17
    v_cvt_pk_bf16_f32 v17, v18, v19
    v_cvt_pk_bf16_f32 v18, v20, v21
    v_cvt_pk_bf16_f32 v19, v22, v23
    v_mfma_f32_32x32x16_bf16 v[136:151], v[232:235], v[208:211], v[136:151]
    ds_read_b64_tr_b16 v[220:221], v247 offset:49664
    ds_read_b64_tr_b16 v[222:223], v247 offset:51200
    v_exp_f32 v24, v24
    v_exp_f32 v25, v25
    s_waitcnt lgkmcnt(2)
    v_mfma_f32_32x32x16_bf16 v[48:63], v[84:87], v[16:19], 0
    s_setprio 3
    ds_read_b128 v[80:83], v11 offset:1024
    s_mov_b32 s64, s20
    s_and_b32 s65, s21, 0xffff
    s_mov_b32 s66, 0x158000
    s_mov_b32 s67, 0x20000
    s_mov_b32 s48, s22
    s_and_b32 s49, s23, 0xffff
    s_mov_b32 s50, 0x400
    s_mov_b32 s51, 0x20000
    s_mov_b32 s84, 0x7b800000
    v_exp_f32 v26, v26
    v_exp_f32 v27, v27
    v_mfma_f32_32x32x16_bf16 v[152:167], v[232:235], v[212:215], v[152:167]
    ds_read_b64_tr_b16 v[224:225], v248 offset:49664
    ds_read_b64_tr_b16 v[226:227], v248 offset:51200
    v_exp_f32 v28, v28
    v_exp_f32 v29, v29
    v_mfma_f32_32x32x16_bf16 v[168:183], v[236:239], v[208:211], v[168:183]
    v_exp_f32 v30, v30
    v_exp_f32 v31, v31
    v_mfma_f32_32x32x16_bf16 v[184:199], v[236:239], v[212:215], v[184:199]
    v_cvt_pk_bf16_f32 v24, v24, v25
    v_cvt_pk_bf16_f32 v25, v26, v27
    v_cvt_pk_bf16_f32 v26, v28, v29
    v_cvt_pk_bf16_f32 v27, v30, v31
    v_exp_f32 v32, v32
    v_exp_f32 v33, v33
    v_mfma_f32_32x32x16_bf16 v[48:63], v[88:91], v[24:27], v[48:63]
    s_setprio 3
    v_exp_f32 v34, v34
    v_exp_f32 v35, v35
    v_mfma_f32_32x32x16_bf16 v[104:119], v[216:219], v[200:203], v[104:119]
    ds_read_b128 v[208:211], v244 offset:160
    ds_read_b64_tr_b16 v[228:229], v246 offset:55808
    v_exp_f32 v36, v36
    v_exp_f32 v37, v37
    v_mfma_f32_32x32x16_bf16 v[120:135], v[216:219], v[204:207], v[120:135]
    ds_read_b64_tr_b16 v[230:231], v246 offset:57344
    ds_read_b128 v[212:215], v244 offset:33440
    v_exp_f32 v38, v38
    v_exp_f32 v39, v39
    s_waitcnt lgkmcnt(3)
    v_mfma_f32_32x32x16_bf16 v[16:31], v[80:83], v[92:95], 0
    s_lshl_b32 s8, s74, 10
    s_lshl_b32 s7, s73, 5
    s_add_u32 s7, s7, s72
    s_lshl_b32 s7, s7, 2
    s_add_u32 s7, s7, s8
    s_add_u32 s7, s7, 0x26000
    s_add_u32 s8, s8, 0x26000
    s_lshl_b32 s12, s72, 14
    s_lshl_b32 s77, s73, 7
    s_add_u32 s12, s12, s77
    s_lshl_b32 s15, s72, 11
    v_cvt_pk_bf16_f32 v32, v32, v33
    v_cvt_pk_bf16_f32 v33, v34, v35
    v_cvt_pk_bf16_f32 v34, v36, v37
    v_cvt_pk_bf16_f32 v35, v38, v39
    v_mfma_f32_32x32x16_bf16 v[136:151], v[220:223], v[200:203], v[136:151]
    ds_read_b64_tr_b16 v[232:233], v247 offset:55808
    ds_read_b64_tr_b16 v[234:235], v247 offset:57344
    v_exp_f32 v40, v40
    v_exp_f32 v41, v41
    v_mfma_f32_32x32x16_bf16 v[64:79], v[84:87], v[32:35], 0
    s_setprio 2
    s_mov_b64 exec, s[28:29]
    ds_read_b128 v[84:87], v12 offset:1024
    s_mov_b64 exec, -1
    s_mul_i32 s80, s73, 11
    s_min_u32 s80, s80, 76
    s_cmp_ge_u32 s73, 6
    s_cselect_b32 s81, 10, 11
    v_exp_f32 v42, v42
    v_exp_f32 v43, v43
    v_mfma_f32_32x32x16_bf16 v[152:167], v[220:223], v[204:207], v[152:167]
    ds_read_b64_tr_b16 v[236:237], v248 offset:55808
    ds_read_b64_tr_b16 v[238:239], v248 offset:57344
    v_exp_f32 v44, v44
    v_exp_f32 v45, v45
    v_mfma_f32_32x32x16_bf16 v[168:183], v[224:227], v[200:203], v[168:183]
    v_exp_f32 v46, v46
    v_exp_f32 v47, v47
    v_mfma_f32_32x32x16_bf16 v[184:199], v[224:227], v[204:207], v[184:199]
    v_cvt_pk_bf16_f32 v40, v40, v41
    v_cvt_pk_bf16_f32 v41, v42, v43
    v_cvt_pk_bf16_f32 v42, v44, v45
    v_cvt_pk_bf16_f32 v43, v46, v47
    v_exp_f32 v16, v16
    v_exp_f32 v17, v17
    v_mfma_f32_32x32x16_bf16 v[64:79], v[88:91], v[40:43], v[64:79]
    s_mov_b64 exec, s[28:29]
    ds_read_b128 v[88:91], v12 offset:1536
    s_mov_b64 exec, -1
    s_setprio 1
    v_exp_f32 v18, v18
    v_exp_f32 v19, v19
    v_exp_f32 v20, v20
    v_exp_f32 v21, v21
    v_exp_f32 v22, v22
    v_exp_f32 v23, v23
    v_mfma_f32_32x32x16_bf16 v[32:47], v[80:83], v[96:99], 0
    s_mul_i32 s76, s72, 3
    s_mul_i32 s77, s74, 236
    s_add_u32 s77, s77, s80
    s_add_u32 s78, s76, 0
    s_add_u32 s4, s77, s78
    s_lshl_b32 s4, s4, 10
    s_add_u32 s4, s4, 0x400000
    s_cmp_lt_u32 s78, s81
    s_cselect_b32 s4, s4, 0x40000000
    v_cvt_pk_bf16_f32 v16, v16, v17
    v_cvt_pk_bf16_f32 v17, v18, v19
    v_cvt_pk_bf16_f32 v18, v20, v21
    v_cvt_pk_bf16_f32 v19, v22, v23
    v_exp_f32 v24, v24
    v_exp_f32 v25, v25
    s_waitcnt lgkmcnt(0)
    v_mfma_f32_32x32x16_bf16 v[48:63], v[84:87], v[16:19], v[48:63]
    s_barrier
    s_setprio 3
    ds_read_b128 v[80:83], v11 offset:8192
    s_add_u32 s78, s76, 1
    s_add_u32 s5, s77, s78
    s_lshl_b32 s5, s5, 10
    s_add_u32 s5, s5, 0x400000
    s_cmp_lt_u32 s78, s81
    s_cselect_b32 s5, s5, 0x40000000
    v_exp_f32 v26, v26
    v_exp_f32 v27, v27
    v_mfma_f32_32x32x16_bf16 v[104:119], v[228:231], v[208:211], v[104:119]
    ds_read_b128 v[200:203], v244 offset:192
    ds_read_b64_tr_b16 v[216:217], v246 offset:0
    v_exp_f32 v28, v28
    v_exp_f32 v29, v29
    v_mfma_f32_32x32x16_bf16 v[120:135], v[228:231], v[212:215], v[120:135]
    ds_read_b64_tr_b16 v[218:219], v246 offset:1536
    ds_read_b128 v[204:207], v244 offset:33472
    v_exp_f32 v30, v30
    v_exp_f32 v31, v31
    v_mfma_f32_32x32x16_bf16 v[136:151], v[232:235], v[208:211], v[136:151]
    ds_read_b64_tr_b16 v[220:221], v247 offset:0
    ds_read_b64_tr_b16 v[222:223], v247 offset:1536
    v_cvt_pk_bf16_f32 v24, v24, v25
    v_cvt_pk_bf16_f32 v25, v26, v27
    v_cvt_pk_bf16_f32 v26, v28, v29
    v_cvt_pk_bf16_f32 v27, v30, v31
    v_exp_f32 v32, v32
    v_exp_f32 v33, v33
    v_mfma_f32_32x32x16_bf16 v[48:63], v[88:91], v[24:27], v[48:63]
    s_setprio 3
    v_exp_f32 v34, v34
    v_exp_f32 v35, v35
    v_mfma_f32_32x32x16_bf16 v[152:167], v[232:235], v[212:215], v[152:167]
    ds_read_b64_tr_b16 v[224:225], v248 offset:0
    ds_read_b64_tr_b16 v[226:227], v248 offset:1536
    v_exp_f32 v36, v36
    v_exp_f32 v37, v37
    v_mfma_f32_32x32x16_bf16 v[168:183], v[236:239], v[208:211], v[168:183]
    v_exp_f32 v38, v38
    v_exp_f32 v39, v39
    s_waitcnt lgkmcnt(2)
    v_mfma_f32_32x32x16_bf16 v[16:31], v[80:83], v[92:95], 0
    s_add_u32 s78, s76, 2
    s_add_u32 s6, s77, s78
    s_lshl_b32 s6, s6, 10
    s_add_u32 s6, s6, 0x400000
    s_cmp_lt_u32 s78, s81
    s_cselect_b32 s6, s6, 0x40000000
    v_cvt_pk_bf16_f32 v32, v32, v33
    v_cvt_pk_bf16_f32 v33, v34, v35
    v_cvt_pk_bf16_f32 v34, v36, v37
    v_cvt_pk_bf16_f32 v35, v38, v39
    v_mfma_f32_32x32x16_bf16 v[184:199], v[236:239], v[212:215], v[184:199]
    v_exp_f32 v40, v40
    v_exp_f32 v41, v41
    v_mfma_f32_32x32x16_bf16 v[64:79], v[84:87], v[32:35], v[64:79]
    s_setprio 2
    s_mov_b64 exec, s[28:29]
    ds_read_b128 v[84:87], v13 offset:0
    s_mov_b64 exec, -1
    s_lshr_b32 s76, s2, 3
    s_lshl_b32 s76, s76, 2
    s_add_u32 s76, s76, s72
    s_cmp_lt_u32 s76, 86
    s_cselect_b32 s40, s64, s60
    s_cselect_b32 s41, s65, s61
    s_cselect_b32 s42, s66, s62
    s_cselect_b32 s77, 0, 86
    s_mov_b32 s43, 0x20000
    s_sub_u32 s76, s76, s77
    s_lshl_b32 s76, s76, 14
    s_and_b32 s77, s2, 1
    s_lshl_b32 s77, s77, 9
    s_add_u32 s76, s76, s77
    v_exp_f32 v42, v42
    v_exp_f32 v43, v43
    v_mfma_f32_32x32x16_bf16 v[104:119], v[216:219], v[200:203], v[104:119]
    ds_read_b128 v[208:211], v244 offset:224
    ds_read_b64_tr_b16 v[228:229], v246 offset:6144
    v_exp_f32 v44, v44
    v_exp_f32 v45, v45
    v_mfma_f32_32x32x16_bf16 v[120:135], v[216:219], v[204:207], v[120:135]
    ds_read_b64_tr_b16 v[230:231], v246 offset:7680
    ds_read_b128 v[212:215], v244 offset:33504
    v_exp_f32 v46, v46
    v_exp_f32 v47, v47
    v_mfma_f32_32x32x16_bf16 v[136:151], v[220:223], v[200:203], v[136:151]
    ds_read_b64_tr_b16 v[232:233], v247 offset:6144
    ds_read_b64_tr_b16 v[234:235], v247 offset:7680
    v_cvt_pk_bf16_f32 v40, v40, v41
    v_cvt_pk_bf16_f32 v41, v42, v43
    v_cvt_pk_bf16_f32 v42, v44, v45
    v_cvt_pk_bf16_f32 v43, v46, v47
    v_exp_f32 v16, v16
    v_exp_f32 v17, v17
    v_mfma_f32_32x32x16_bf16 v[64:79], v[88:91], v[40:43], v[64:79]
    s_mov_b64 exec, s[28:29]
    ds_read_b128 v[88:91], v13 offset:512
    s_mov_b64 exec, -1
    s_setprio 1
    v_exp_f32 v18, v18
    v_exp_f32 v19, v19
    v_mfma_f32_32x32x16_bf16 v[152:167], v[220:223], v[204:207], v[152:167]
    ds_read_b64_tr_b16 v[236:237], v248 offset:6144
    ds_read_b64_tr_b16 v[238:239], v248 offset:7680
    v_exp_f32 v20, v20
    v_exp_f32 v21, v21
    s_waitcnt lgkmcnt(2)
    v_mfma_f32_32x32x16_bf16 v[168:183], v[224:227], v[200:203], v[168:183]
    v_exp_f32 v22, v22
    v_exp_f32 v23, v23
    v_mfma_f32_32x32x16_bf16 v[32:47], v[80:83], v[96:99], 0
    v_lshrrev_b32 v6, 2, v2
    v_lshlrev_b32 v6, 10, v6
    v_and_b32 v7, 3, v2
    v_lshl_add_u32 v6, v7, 7, v6
    v_add_u32 v243, s76, v6
    v_cvt_pk_bf16_f32 v16, v16, v17
    v_cvt_pk_bf16_f32 v17, v18, v19
    v_cvt_pk_bf16_f32 v18, v20, v21
    v_cvt_pk_bf16_f32 v19, v22, v23
    v_exp_f32 v24, v24
    v_exp_f32 v25, v25
    v_mfma_f32_32x32x16_bf16 v[48:63], v[84:87], v[16:19], v[48:63]
    v_mfma_f32_32x32x16_bf16 v[184:199], v[224:227], v[204:207], v[184:199]
    s_waitcnt lgkmcnt(0)
    s_barrier
    s_setprio 3
    ds_read_b128 v[80:83], v11 offset:9216
    v_exp_f32 v26, v26
    v_exp_f32 v27, v27
    v_mfma_f32_32x32x16_bf16 v[104:119], v[228:231], v[208:211], v[104:119]
    ds_read_b128 v[200:203], v244 offset:256
    ds_read_b64_tr_b16 v[216:217], v246 offset:24832
    v_exp_f32 v28, v28
    v_exp_f32 v29, v29
    v_mfma_f32_32x32x16_bf16 v[120:135], v[228:231], v[212:215], v[120:135]
    ds_read_b64_tr_b16 v[218:219], v246 offset:26368
    ds_read_b128 v[204:207], v244 offset:33536
    v_exp_f32 v30, v30
    v_exp_f32 v31, v31
    v_mfma_f32_32x32x16_bf16 v[136:151], v[232:235], v[208:211], v[136:151]
    ds_read_b64_tr_b16 v[220:221], v247 offset:24832
    ds_read_b64_tr_b16 v[222:223], v247 offset:26368
    v_cvt_pk_bf16_f32 v24, v24, v25
    v_cvt_pk_bf16_f32 v25, v26, v27
    v_cvt_pk_bf16_f32 v26, v28, v29
    v_cvt_pk_bf16_f32 v27, v30, v31
    v_exp_f32 v32, v32
    v_exp_f32 v33, v33
    v_mfma_f32_32x32x16_bf16 v[48:63], v[88:91], v[24:27], v[48:63]
    s_setprio 3
    v_exp_f32 v34, v34
    v_exp_f32 v35, v35
    v_mfma_f32_32x32x16_bf16 v[152:167], v[232:235], v[212:215], v[152:167]
    ds_read_b64_tr_b16 v[224:225], v248 offset:24832
    ds_read_b64_tr_b16 v[226:227], v248 offset:26368
    v_exp_f32 v36, v36
    v_exp_f32 v37, v37
    v_mfma_f32_32x32x16_bf16 v[168:183], v[236:239], v[208:211], v[168:183]
    v_exp_f32 v38, v38
    v_exp_f32 v39, v39
    s_waitcnt lgkmcnt(2)
    v_mfma_f32_32x32x16_bf16 v[16:31], v[80:83], v[92:95], 0
    v_cvt_pk_bf16_f32 v32, v32, v33
    v_cvt_pk_bf16_f32 v33, v34, v35
    v_cvt_pk_bf16_f32 v34, v36, v37
    v_cvt_pk_bf16_f32 v35, v38, v39
    v_mfma_f32_32x32x16_bf16 v[184:199], v[236:239], v[212:215], v[184:199]
    v_exp_f32 v40, v40
    v_exp_f32 v41, v41
    v_mfma_f32_32x32x16_bf16 v[64:79], v[84:87], v[32:35], v[64:79]
    s_setprio 2
    s_mov_b64 exec, s[28:29]
    ds_read_b128 v[84:87], v13 offset:1024
    s_mov_b64 exec, -1
    v_exp_f32 v42, v42
    v_exp_f32 v43, v43
    v_mfma_f32_32x32x16_bf16 v[104:119], v[216:219], v[200:203], v[104:119]
    ds_read_b128 v[208:211], v244 offset:288
    ds_read_b64_tr_b16 v[228:229], v246 offset:30976
    v_exp_f32 v44, v44
    v_exp_f32 v45, v45
    v_mfma_f32_32x32x16_bf16 v[120:135], v[216:219], v[204:207], v[120:135]
    ds_read_b64_tr_b16 v[230:231], v246 offset:32512
    ds_read_b128 v[212:215], v244 offset:33568
    v_exp_f32 v46, v46
    v_exp_f32 v47, v47
    v_mfma_f32_32x32x16_bf16 v[136:151], v[220:223], v[200:203], v[136:151]
    ds_read_b64_tr_b16 v[232:233], v247 offset:30976
    ds_read_b64_tr_b16 v[234:235], v247 offset:32512
    v_cvt_pk_bf16_f32 v40, v40, v41
    v_cvt_pk_bf16_f32 v41, v42, v43
    v_cvt_pk_bf16_f32 v42, v44, v45
    v_cvt_pk_bf16_f32 v43, v46, v47
    v_exp_f32 v16, v16
    v_exp_f32 v17, v17
    v_mfma_f32_32x32x16_bf16 v[64:79], v[88:91], v[40:43], v[64:79]
    s_mov_b64 exec, s[28:29]
    ds_read_b128 v[88:91], v13 offset:1536
    s_mov_b64 exec, -1
    s_setprio 1
    v_exp_f32 v18, v18
    v_exp_f32 v19, v19
    v_mfma_f32_32x32x16_bf16 v[152:167], v[220:223], v[204:207], v[152:167]
    ds_read_b64_tr_b16 v[236:237], v248 offset:30976
    ds_read_b64_tr_b16 v[238:239], v248 offset:32512
    v_exp_f32 v20, v20
    v_exp_f32 v21, v21
    s_waitcnt lgkmcnt(2)
    v_mfma_f32_32x32x16_bf16 v[168:183], v[224:227], v[200:203], v[168:183]
    v_exp_f32 v22, v22
    v_exp_f32 v23, v23
    v_mfma_f32_32x32x16_bf16 v[32:47], v[80:83], v[96:99], 0
    v_mov_b32 v100, -1
    v_mov_b32 v101, -1
    v_mov_b32 v102, -1
    v_mov_b32 v103, -1
    buffer_store_dwordx4 v[100:103], v3, s[52:55], s9 offen sc1
    v_cvt_pk_bf16_f32 v16, v16, v17
    v_cvt_pk_bf16_f32 v17, v18, v19
    v_cvt_pk_bf16_f32 v18, v20, v21
    v_cvt_pk_bf16_f32 v19, v22, v23
    v_exp_f32 v24, v24
    v_exp_f32 v25, v25
    v_mfma_f32_32x32x16_bf16 v[48:63], v[84:87], v[16:19], v[48:63]
    v_mfma_f32_32x32x16_bf16 v[184:199], v[224:227], v[204:207], v[184:199]
    s_waitcnt lgkmcnt(0)
    s_barrier
    s_setprio 3
    ds_read_b128 v[80:83], v11 offset:0
    v_exp_f32 v26, v26
    v_exp_f32 v27, v27
    v_mfma_f32_32x32x16_bf16 v[104:119], v[228:231], v[208:211], v[104:119]
    ds_read_b128 v[200:203], v244 offset:320
    ds_read_b64_tr_b16 v[216:217], v246 offset:49664
    v_exp_f32 v28, v28
    v_exp_f32 v29, v29
    v_mfma_f32_32x32x16_bf16 v[120:135], v[228:231], v[212:215], v[120:135]
    ds_read_b64_tr_b16 v[218:219], v246 offset:51200
    ds_read_b128 v[204:207], v244 offset:33600
    v_exp_f32 v30, v30
    v_exp_f32 v31, v31
    v_mfma_f32_32x32x16_bf16 v[136:151], v[232:235], v[208:211], v[136:151]
    ds_read_b64_tr_b16 v[220:221], v247 offset:49664
    ds_read_b64_tr_b16 v[222:223], v247 offset:51200
    v_cvt_pk_bf16_f32 v24, v24, v25
    v_cvt_pk_bf16_f32 v25, v26, v27
    v_cvt_pk_bf16_f32 v26, v28, v29
    v_cvt_pk_bf16_f32 v27, v30, v31
    v_exp_f32 v32, v32
    v_exp_f32 v33, v33
    v_mfma_f32_32x32x16_bf16 v[48:63], v[88:91], v[24:27], v[48:63]
    s_setprio 3
    v_exp_f32 v34, v34
    v_exp_f32 v35, v35
    v_mfma_f32_32x32x16_bf16 v[152:167], v[232:235], v[212:215], v[152:167]
    ds_read_b64_tr_b16 v[224:225], v248 offset:49664
    ds_read_b64_tr_b16 v[226:227], v248 offset:51200
    v_exp_f32 v36, v36
    v_exp_f32 v37, v37
    v_mfma_f32_32x32x16_bf16 v[168:183], v[236:239], v[208:211], v[168:183]
    v_exp_f32 v38, v38
    v_exp_f32 v39, v39
    s_waitcnt lgkmcnt(2)
    v_mfma_f32_32x32x16_bf16 v[16:31], v[80:83], v[92:95], 0
    v_cvt_pk_bf16_f32 v32, v32, v33
    v_cvt_pk_bf16_f32 v33, v34, v35
    v_cvt_pk_bf16_f32 v34, v36, v37
    v_cvt_pk_bf16_f32 v35, v38, v39
    v_mfma_f32_32x32x16_bf16 v[184:199], v[236:239], v[212:215], v[184:199]
    v_exp_f32 v40, v40
    v_exp_f32 v41, v41
    v_mfma_f32_32x32x16_bf16 v[64:79], v[84:87], v[32:35], v[64:79]
    s_setprio 2
    s_mov_b64 exec, s[28:29]
    ds_read_b128 v[84:87], v12 offset:0
    s_mov_b64 exec, -1
    v_exp_f32 v42, v42
    v_exp_f32 v43, v43
    v_mfma_f32_32x32x16_bf16 v[104:119], v[216:219], v[200:203], v[104:119]
    ds_read_b128 v[208:211], v244 offset:352
    ds_read_b64_tr_b16 v[228:229], v246 offset:55808
    v_exp_f32 v44, v44
    v_exp_f32 v45, v45
    v_mfma_f32_32x32x16_bf16 v[120:135], v[216:219], v[204:207], v[120:135]
    ds_read_b64_tr_b16 v[230:231], v246 offset:57344
    ds_read_b128 v[212:215], v244 offset:33632
    v_exp_f32 v46, v46
    v_exp_f32 v47, v47
    v_mfma_f32_32x32x16_bf16 v[136:151], v[220:223], v[200:203], v[136:151]
    ds_read_b64_tr_b16 v[232:233], v247 offset:55808
    ds_read_b64_tr_b16 v[234:235], v247 offset:57344
    v_cvt_pk_bf16_f32 v40, v40, v41
    v_cvt_pk_bf16_f32 v41, v42, v43
    v_cvt_pk_bf16_f32 v42, v44, v45
    v_cvt_pk_bf16_f32 v43, v46, v47
    v_exp_f32 v16, v16
    v_exp_f32 v17, v17
    v_mfma_f32_32x32x16_bf16 v[64:79], v[88:91], v[40:43], v[64:79]
    s_mov_b64 exec, s[28:29]
    ds_read_b128 v[88:91], v12 offset:512
    s_mov_b64 exec, -1
    s_setprio 1
    v_exp_f32 v18, v18
    v_exp_f32 v19, v19
    v_mfma_f32_32x32x16_bf16 v[152:167], v[220:223], v[204:207], v[152:167]
    ds_read_b64_tr_b16 v[236:237], v248 offset:55808
    ds_read_b64_tr_b16 v[238:239], v248 offset:57344
    v_exp_f32 v20, v20
    v_exp_f32 v21, v21
    s_waitcnt lgkmcnt(2)
    v_mfma_f32_32x32x16_bf16 v[168:183], v[224:227], v[200:203], v[168:183]
    v_exp_f32 v22, v22
    v_exp_f32 v23, v23
    v_mfma_f32_32x32x16_bf16 v[32:47], v[80:83], v[96:99], 0
    buffer_store_dwordx4 v[100:103], v3, s[52:55], s9 offen offset:1024 sc1
    v_cvt_pk_bf16_f32 v16, v16, v17
    v_cvt_pk_bf16_f32 v17, v18, v19
    v_cvt_pk_bf16_f32 v18, v20, v21
    v_cvt_pk_bf16_f32 v19, v22, v23
    v_exp_f32 v24, v24
    v_exp_f32 v25, v25
    v_mfma_f32_32x32x16_bf16 v[48:63], v[84:87], v[16:19], v[48:63]
    v_mfma_f32_32x32x16_bf16 v[184:199], v[224:227], v[204:207], v[184:199]
    s_waitcnt lgkmcnt(0)
    s_barrier
    s_setprio 3
    ds_read_b128 v[80:83], v11 offset:1024
    v_exp_f32 v26, v26
    v_exp_f32 v27, v27
    v_mfma_f32_32x32x16_bf16 v[104:119], v[228:231], v[208:211], v[104:119]
    ds_read_b128 v[200:203], v244 offset:384
    ds_read_b64_tr_b16 v[216:217], v246 offset:0
    v_exp_f32 v28, v28
    v_exp_f32 v29, v29
    v_mfma_f32_32x32x16_bf16 v[120:135], v[228:231], v[212:215], v[120:135]
    ds_read_b64_tr_b16 v[218:219], v246 offset:1536
    ds_read_b128 v[204:207], v244 offset:33664
    v_exp_f32 v30, v30
    v_exp_f32 v31, v31
    v_mfma_f32_32x32x16_bf16 v[136:151], v[232:235], v[208:211], v[136:151]
    ds_read_b64_tr_b16 v[220:221], v247 offset:0
    ds_read_b64_tr_b16 v[222:223], v247 offset:1536
    v_cvt_pk_bf16_f32 v24, v24, v25
    v_cvt_pk_bf16_f32 v25, v26, v27
    v_cvt_pk_bf16_f32 v26, v28, v29
    v_cvt_pk_bf16_f32 v27, v30, v31
    v_exp_f32 v32, v32
    v_exp_f32 v33, v33
    v_mfma_f32_32x32x16_bf16 v[48:63], v[88:91], v[24:27], v[48:63]
    s_setprio 3
    v_exp_f32 v34, v34
    v_exp_f32 v35, v35
    v_mfma_f32_32x32x16_bf16 v[152:167], v[232:235], v[212:215], v[152:167]
    ds_read_b64_tr_b16 v[224:225], v248 offset:0
    ds_read_b64_tr_b16 v[226:227], v248 offset:1536
    v_exp_f32 v36, v36
    v_exp_f32 v37, v37
    v_mfma_f32_32x32x16_bf16 v[168:183], v[236:239], v[208:211], v[168:183]
    v_exp_f32 v38, v38
    v_exp_f32 v39, v39
    s_waitcnt lgkmcnt(2)
    v_mfma_f32_32x32x16_bf16 v[16:31], v[80:83], v[92:95], 0
    v_cvt_pk_bf16_f32 v32, v32, v33
    v_cvt_pk_bf16_f32 v33, v34, v35
    v_cvt_pk_bf16_f32 v34, v36, v37
    v_cvt_pk_bf16_f32 v35, v38, v39
    v_mfma_f32_32x32x16_bf16 v[184:199], v[236:239], v[212:215], v[184:199]
    v_exp_f32 v40, v40
    v_exp_f32 v41, v41
    v_mfma_f32_32x32x16_bf16 v[64:79], v[84:87], v[32:35], v[64:79]
    s_setprio 2
    s_mov_b64 exec, s[28:29]
    ds_read_b128 v[84:87], v12 offset:1024
    s_mov_b64 exec, -1
    v_exp_f32 v42, v42
    v_exp_f32 v43, v43
    v_mfma_f32_32x32x16_bf16 v[104:119], v[216:219], v[200:203], v[104:119]
    ds_read_b128 v[208:211], v244 offset:416
    ds_read_b64_tr_b16 v[228:229], v246 offset:6144
    v_exp_f32 v44, v44
    v_exp_f32 v45, v45
    v_mfma_f32_32x32x16_bf16 v[120:135], v[216:219], v[204:207], v[120:135]
    ds_read_b64_tr_b16 v[230:231], v246 offset:7680
    ds_read_b128 v[212:215], v244 offset:33696
    v_exp_f32 v46, v46
    v_exp_f32 v47, v47
    v_mfma_f32_32x32x16_bf16 v[136:151], v[220:223], v[200:203], v[136:151]
    ds_read_b64_tr_b16 v[232:233], v247 offset:6144
    ds_read_b64_tr_b16 v[234:235], v247 offset:7680
    v_cvt_pk_bf16_f32 v40, v40, v41
    v_cvt_pk_bf16_f32 v41, v42, v43
    v_cvt_pk_bf16_f32 v42, v44, v45
    v_cvt_pk_bf16_f32 v43, v46, v47
    v_exp_f32 v16, v16
    v_exp_f32 v17, v17
    v_mfma_f32_32x32x16_bf16 v[64:79], v[88:91], v[40:43], v[64:79]
    s_mov_b64 exec, s[28:29]
    ds_read_b128 v[88:91], v12 offset:1536
    s_mov_b64 exec, -1
    s_setprio 1
    v_exp_f32 v18, v18
    v_exp_f32 v19, v19
    v_mfma_f32_32x32x16_bf16 v[152:167], v[220:223], v[204:207], v[152:167]
    ds_read_b64_tr_b16 v[236:237], v248 offset:6144
    ds_read_b64_tr_b16 v[238:239], v248 offset:7680
    v_exp_f32 v20, v20
    v_exp_f32 v21, v21
    s_waitcnt lgkmcnt(2)
    v_mfma_f32_32x32x16_bf16 v[168:183], v[224:227], v[200:203], v[168:183]
    v_exp_f32 v22, v22
    v_exp_f32 v23, v23
    v_mfma_f32_32x32x16_bf16 v[32:47], v[80:83], v[96:99], 0
    v_cvt_pk_bf16_f32 v16, v16, v17
    v_cvt_pk_bf16_f32 v17, v18, v19
    v_cvt_pk_bf16_f32 v18, v20, v21
    v_cvt_pk_bf16_f32 v19, v22, v23
    v_exp_f32 v24, v24
    v_exp_f32 v25, v25
    v_mfma_f32_32x32x16_bf16 v[48:63], v[84:87], v[16:19], v[48:63]
    v_mfma_f32_32x32x16_bf16 v[184:199], v[224:227], v[204:207], v[184:199]
    s_waitcnt lgkmcnt(0)
    s_barrier
    s_setprio 3
    ds_read_b128 v[80:83], v11 offset:8192
    v_exp_f32 v26, v26
    v_exp_f32 v27, v27
    v_mfma_f32_32x32x16_bf16 v[104:119], v[228:231], v[208:211], v[104:119]
    ds_read_b128 v[200:203], v244 offset:448
    ds_read_b64_tr_b16 v[216:217], v246 offset:24832
    v_exp_f32 v28, v28
    v_exp_f32 v29, v29
    v_mfma_f32_32x32x16_bf16 v[120:135], v[228:231], v[212:215], v[120:135]
    ds_read_b64_tr_b16 v[218:219], v246 offset:26368
    ds_read_b128 v[204:207], v244 offset:33728
    v_exp_f32 v30, v30
    v_exp_f32 v31, v31
    v_mfma_f32_32x32x16_bf16 v[136:151], v[232:235], v[208:211], v[136:151]
    ds_read_b64_tr_b16 v[220:221], v247 offset:24832
    ds_read_b64_tr_b16 v[222:223], v247 offset:26368
    v_cvt_pk_bf16_f32 v24, v24, v25
    v_cvt_pk_bf16_f32 v25, v26, v27
    v_cvt_pk_bf16_f32 v26, v28, v29
    v_cvt_pk_bf16_f32 v27, v30, v31
    v_exp_f32 v32, v32
    v_exp_f32 v33, v33
    v_mfma_f32_32x32x16_bf16 v[48:63], v[88:91], v[24:27], v[48:63]
    s_setprio 3
    v_exp_f32 v34, v34
    v_exp_f32 v35, v35
    v_mfma_f32_32x32x16_bf16 v[152:167], v[232:235], v[212:215], v[152:167]
    ds_read_b64_tr_b16 v[224:225], v248 offset:24832
    ds_read_b64_tr_b16 v[226:227], v248 offset:26368
    v_exp_f32 v36, v36
    v_exp_f32 v37, v37
    v_mfma_f32_32x32x16_bf16 v[168:183], v[236:239], v[208:211], v[168:183]
    v_exp_f32 v38, v38
    v_exp_f32 v39, v39
    s_waitcnt lgkmcnt(2)
    v_mfma_f32_32x32x16_bf16 v[16:31], v[80:83], v[92:95], 0
    v_cvt_pk_bf16_f32 v32, v32, v33
    v_cvt_pk_bf16_f32 v33, v34, v35
    v_cvt_pk_bf16_f32 v34, v36, v37
    v_cvt_pk_bf16_f32 v35, v38, v39
    v_mfma_f32_32x32x16_bf16 v[184:199], v[236:239], v[212:215], v[184:199]
    v_exp_f32 v40, v40
    v_exp_f32 v41, v41
    v_mfma_f32_32x32x16_bf16 v[64:79], v[84:87], v[32:35], v[64:79]
    s_setprio 2
    s_mov_b64 exec, s[28:29]
    ds_read_b128 v[84:87], v13 offset:0
    s_mov_b64 exec, -1
    v_exp_f32 v42, v42
    v_exp_f32 v43, v43
    v_mfma_f32_32x32x16_bf16 v[104:119], v[216:219], v[200:203], v[104:119]
    ds_read_b128 v[208:211], v244 offset:480
    ds_read_b64_tr_b16 v[228:229], v246 offset:30976
    v_exp_f32 v44, v44
    v_exp_f32 v45, v45
    v_mfma_f32_32x32x16_bf16 v[120:135], v[216:219], v[204:207], v[120:135]
    ds_read_b64_tr_b16 v[230:231], v246 offset:32512
    ds_read_b128 v[212:215], v244 offset:33760
    v_exp_f32 v46, v46
    v_exp_f32 v47, v47
    v_mfma_f32_32x32x16_bf16 v[136:151], v[220:223], v[200:203], v[136:151]
    ds_read_b64_tr_b16 v[232:233], v247 offset:30976
    ds_read_b64_tr_b16 v[234:235], v247 offset:32512
    v_cvt_pk_bf16_f32 v40, v40, v41
    v_cvt_pk_bf16_f32 v41, v42, v43
    v_cvt_pk_bf16_f32 v42, v44, v45
    v_cvt_pk_bf16_f32 v43, v46, v47
    v_exp_f32 v16, v16
    v_exp_f32 v17, v17
    v_mfma_f32_32x32x16_bf16 v[64:79], v[88:91], v[40:43], v[64:79]
    s_mov_b64 exec, s[28:29]
    ds_read_b128 v[88:91], v13 offset:512
    s_mov_b64 exec, -1
    s_setprio 1
    v_exp_f32 v18, v18
    v_exp_f32 v19, v19
    v_mfma_f32_32x32x16_bf16 v[152:167], v[220:223], v[204:207], v[152:167]
    ds_read_b64_tr_b16 v[236:237], v248 offset:30976
    ds_read_b64_tr_b16 v[238:239], v248 offset:32512
    v_exp_f32 v20, v20
    v_exp_f32 v21, v21
    s_waitcnt lgkmcnt(2)
    v_mfma_f32_32x32x16_bf16 v[168:183], v[224:227], v[200:203], v[168:183]
    v_exp_f32 v22, v22
    v_exp_f32 v23, v23
    v_mfma_f32_32x32x16_bf16 v[32:47], v[80:83], v[96:99], 0
    v_cvt_pk_bf16_f32 v16, v16, v17
    v_cvt_pk_bf16_f32 v17, v18, v19
    v_cvt_pk_bf16_f32 v18, v20, v21
    v_cvt_pk_bf16_f32 v19, v22, v23
    v_exp_f32 v24, v24
    v_exp_f32 v25, v25
    v_mfma_f32_32x32x16_bf16 v[48:63], v[84:87], v[16:19], v[48:63]
    v_mfma_f32_32x32x16_bf16 v[184:199], v[224:227], v[204:207], v[184:199]
    s_waitcnt lgkmcnt(0)
    s_barrier
    s_setprio 3
    ds_read_b128 v[80:83], v11 offset:9216
    v_exp_f32 v26, v26
    v_exp_f32 v27, v27
    v_mfma_f32_32x32x16_bf16 v[104:119], v[228:231], v[208:211], v[104:119]
    ds_read_b128 v[200:203], v244 offset:512
    ds_read_b64_tr_b16 v[216:217], v246 offset:49664
    v_exp_f32 v28, v28
    v_exp_f32 v29, v29
    v_mfma_f32_32x32x16_bf16 v[120:135], v[228:231], v[212:215], v[120:135]
    ds_read_b64_tr_b16 v[218:219], v246 offset:51200
    ds_read_b128 v[204:207], v244 offset:33792
    v_exp_f32 v30, v30
    v_exp_f32 v31, v31
    v_mfma_f32_32x32x16_bf16 v[136:151], v[232:235], v[208:211], v[136:151]
    ds_read_b64_tr_b16 v[220:221], v247 offset:49664
    ds_read_b64_tr_b16 v[222:223], v247 offset:51200
    v_cvt_pk_bf16_f32 v24, v24, v25
    v_cvt_pk_bf16_f32 v25, v26, v27
    v_cvt_pk_bf16_f32 v26, v28, v29
    v_cvt_pk_bf16_f32 v27, v30, v31
    v_exp_f32 v32, v32
    v_exp_f32 v33, v33
    v_mfma_f32_32x32x16_bf16 v[48:63], v[88:91], v[24:27], v[48:63]
    s_setprio 3
    v_exp_f32 v34, v34
    v_exp_f32 v35, v35
    v_mfma_f32_32x32x16_bf16 v[152:167], v[232:235], v[212:215], v[152:167]
    ds_read_b64_tr_b16 v[224:225], v248 offset:49664
    ds_read_b64_tr_b16 v[226:227], v248 offset:51200
    v_exp_f32 v36, v36
    v_exp_f32 v37, v37
    v_mfma_f32_32x32x16_bf16 v[168:183], v[236:239], v[208:211], v[168:183]
    v_exp_f32 v38, v38
    v_exp_f32 v39, v39
    s_waitcnt lgkmcnt(2)
    v_mfma_f32_32x32x16_bf16 v[16:31], v[80:83], v[92:95], 0
    v_cvt_pk_bf16_f32 v32, v32, v33
    v_cvt_pk_bf16_f32 v33, v34, v35
    v_cvt_pk_bf16_f32 v34, v36, v37
    v_cvt_pk_bf16_f32 v35, v38, v39
    v_mfma_f32_32x32x16_bf16 v[184:199], v[236:239], v[212:215], v[184:199]
    v_exp_f32 v40, v40
    v_exp_f32 v41, v41
    v_mfma_f32_32x32x16_bf16 v[64:79], v[84:87], v[32:35], v[64:79]
    s_setprio 2
    s_mov_b64 exec, s[28:29]
    ds_read_b128 v[84:87], v13 offset:1024
    s_mov_b64 exec, -1
    v_exp_f32 v42, v42
    v_exp_f32 v43, v43
    v_mfma_f32_32x32x16_bf16 v[104:119], v[216:219], v[200:203], v[104:119]
    ds_read_b128 v[208:211], v244 offset:544
    ds_read_b64_tr_b16 v[228:229], v246 offset:55808
    v_exp_f32 v44, v44
    v_exp_f32 v45, v45
    v_mfma_f32_32x32x16_bf16 v[120:135], v[216:219], v[204:207], v[120:135]
    ds_read_b64_tr_b16 v[230:231], v246 offset:57344
    ds_read_b128 v[212:215], v244 offset:33824
    v_exp_f32 v46, v46
    v_exp_f32 v47, v47
    v_mfma_f32_32x32x16_bf16 v[136:151], v[220:223], v[200:203], v[136:151]
    ds_read_b64_tr_b16 v[232:233], v247 offset:55808
    ds_read_b64_tr_b16 v[234:235], v247 offset:57344
    v_cvt_pk_bf16_f32 v40, v40, v41
    v_cvt_pk_bf16_f32 v41, v42, v43
    v_cvt_pk_bf16_f32 v42, v44, v45
    v_cvt_pk_bf16_f32 v43, v46, v47
    v_exp_f32 v16, v16
    v_exp_f32 v17, v17
    v_mfma_f32_32x32x16_bf16 v[64:79], v[88:91], v[40:43], v[64:79]
    s_mov_b64 exec, s[28:29]
    ds_read_b128 v[88:91], v13 offset:1536
    s_mov_b64 exec, -1
    s_setprio 1
    v_exp_f32 v18, v18
    v_exp_f32 v19, v19
    v_mfma_f32_32x32x16_bf16 v[152:167], v[220:223], v[204:207], v[152:167]
    ds_read_b64_tr_b16 v[236:237], v248 offset:55808
    ds_read_b64_tr_b16 v[238:239], v248 offset:57344
    v_exp_f32 v20, v20
    v_exp_f32 v21, v21
    s_waitcnt lgkmcnt(2)
    v_mfma_f32_32x32x16_bf16 v[168:183], v[224:227], v[200:203], v[168:183]
    v_exp_f32 v22, v22
    v_exp_f32 v23, v23
    v_mfma_f32_32x32x16_bf16 v[32:47], v[80:83], v[96:99], 0
    v_cvt_pk_bf16_f32 v16, v16, v17
    v_cvt_pk_bf16_f32 v17, v18, v19
    v_cvt_pk_bf16_f32 v18, v20, v21
    v_cvt_pk_bf16_f32 v19, v22, v23
    v_exp_f32 v24, v24
    v_exp_f32 v25, v25
    v_mfma_f32_32x32x16_bf16 v[48:63], v[84:87], v[16:19], v[48:63]
    v_mfma_f32_32x32x16_bf16 v[184:199], v[224:227], v[204:207], v[184:199]
    s_waitcnt lgkmcnt(0)
    s_barrier
    s_setprio 3
    ds_read_b128 v[80:83], v11 offset:0
    v_exp_f32 v26, v26
    v_exp_f32 v27, v27
    v_mfma_f32_32x32x16_bf16 v[104:119], v[228:231], v[208:211], v[104:119]
    ds_read_b128 v[200:203], v244 offset:576
    ds_read_b64_tr_b16 v[216:217], v246 offset:0
    v_exp_f32 v28, v28
    v_exp_f32 v29, v29
    v_mfma_f32_32x32x16_bf16 v[120:135], v[228:231], v[212:215], v[120:135]
    ds_read_b64_tr_b16 v[218:219], v246 offset:1536
    ds_read_b128 v[204:207], v244 offset:33856
    v_exp_f32 v30, v30
    v_exp_f32 v31, v31
    v_mfma_f32_32x32x16_bf16 v[136:151], v[232:235], v[208:211], v[136:151]
    ds_read_b64_tr_b16 v[220:221], v247 offset:0
    ds_read_b64_tr_b16 v[222:223], v247 offset:1536
    v_cvt_pk_bf16_f32 v24, v24, v25
    v_cvt_pk_bf16_f32 v25, v26, v27
    v_cvt_pk_bf16_f32 v26, v28, v29
    v_cvt_pk_bf16_f32 v27, v30, v31
    v_exp_f32 v32, v32
    v_exp_f32 v33, v33
    v_mfma_f32_32x32x16_bf16 v[48:63], v[88:91], v[24:27], v[48:63]
    s_setprio 3
    s_cmp_lg_u32 s72, 0
    s_cbranch_scc1 LF_wp0
    buffer_load_dword v242, v243, s[40:43], 0 offen
LF_wp0:
    v_exp_f32 v34, v34
    v_exp_f32 v35, v35
    v_mfma_f32_32x32x16_bf16 v[152:167], v[232:235], v[212:215], v[152:167]
    ds_read_b64_tr_b16 v[224:225], v248 offset:0
    ds_read_b64_tr_b16 v[226:227], v248 offset:1536
    v_exp_f32 v36, v36
    v_exp_f32 v37, v37
    v_mfma_f32_32x32x16_bf16 v[168:183], v[236:239], v[208:211], v[168:183]
    v_exp_f32 v38, v38
    v_exp_f32 v39, v39
    s_waitcnt lgkmcnt(2)
    v_mfma_f32_32x32x16_bf16 v[16:31], v[80:83], v[92:95], 0
    v_cvt_pk_bf16_f32 v32, v32, v33
    v_cvt_pk_bf16_f32 v33, v34, v35
    v_cvt_pk_bf16_f32 v34, v36, v37
    v_cvt_pk_bf16_f32 v35, v38, v39
    v_mfma_f32_32x32x16_bf16 v[184:199], v[236:239], v[212:215], v[184:199]
    v_exp_f32 v40, v40
    v_exp_f32 v41, v41
    v_mfma_f32_32x32x16_bf16 v[64:79], v[84:87], v[32:35], v[64:79]
    s_setprio 2
    s_mov_b64 exec, s[28:29]
    ds_read_b128 v[84:87], v12 offset:0
    s_mov_b64 exec, -1
    v_exp_f32 v42, v42
    v_exp_f32 v43, v43
    v_mfma_f32_32x32x16_bf16 v[104:119], v[216:219], v[200:203], v[104:119]
    ds_read_b128 v[208:211], v244 offset:608
    ds_read_b64_tr_b16 v[228:229], v246 offset:6144
    v_exp_f32 v44, v44
    v_exp_f32 v45, v45
    v_mfma_f32_32x32x16_bf16 v[120:135], v[216:219], v[204:207], v[120:135]
    ds_read_b64_tr_b16 v[230:231], v246 offset:7680
    ds_read_b128 v[212:215], v244 offset:33888
    v_exp_f32 v46, v46
    v_exp_f32 v47, v47
    v_mfma_f32_32x32x16_bf16 v[136:151], v[220:223], v[200:203], v[136:151]
    ds_read_b64_tr_b16 v[232:233], v247 offset:6144
    ds_read_b64_tr_b16 v[234:235], v247 offset:7680
    v_cvt_pk_bf16_f32 v40, v40, v41
    v_cvt_pk_bf16_f32 v41, v42, v43
    v_cvt_pk_bf16_f32 v42, v44, v45
    v_cvt_pk_bf16_f32 v43, v46, v47
    v_exp_f32 v16, v16
    v_exp_f32 v17, v17
    v_mfma_f32_32x32x16_bf16 v[64:79], v[88:91], v[40:43], v[64:79]
    s_mov_b64 exec, s[28:29]
    ds_read_b128 v[88:91], v12 offset:512
    s_mov_b64 exec, -1
    s_setprio 1
    v_exp_f32 v18, v18
    v_exp_f32 v19, v19
    v_mfma_f32_32x32x16_bf16 v[152:167], v[220:223], v[204:207], v[152:167]
    ds_read_b64_tr_b16 v[236:237], v248 offset:6144
    ds_read_b64_tr_b16 v[238:239], v248 offset:7680
    v_exp_f32 v20, v20
    v_exp_f32 v21, v21
    s_waitcnt lgkmcnt(2)
    v_mfma_f32_32x32x16_bf16 v[168:183], v[224:227], v[200:203], v[168:183]
    v_exp_f32 v22, v22
    v_exp_f32 v23, v23
    v_mfma_f32_32x32x16_bf16 v[32:47], v[80:83], v[96:99], 0
    v_cvt_pk_bf16_f32 v16, v16, v17
    v_cvt_pk_bf16_f32 v17, v18, v19
    v_cvt_pk_bf16_f32 v18, v20, v21
    v_cvt_pk_bf16_f32 v19, v22, v23
    v_exp_f32 v24, v24
    v_exp_f32 v25, v25
    v_mfma_f32_32x32x16_bf16 v[48:63], v[84:87], v[16:19], v[48:63]
    v_mfma_f32_32x32x16_bf16 v[184:199], v[224:227], v[204:207], v[184:199]
    s_waitcnt lgkmcnt(0)
    s_barrier
    s_setprio 3
    ds_read_b128 v[80:83], v11 offset:1024
    v_exp_f32 v26, v26
    v_exp_f32 v27, v27
    v_mfma_f32_32x32x16_bf16 v[104:119], v[228:231], v[208:211], v[104:119]
    ds_read_b128 v[200:203], v244 offset:640
    ds_read_b64_tr_b16 v[216:217], v246 offset:24832
    v_exp_f32 v28, v28
    v_exp_f32 v29, v29
    v_mfma_f32_32x32x16_bf16 v[120:135], v[228:231], v[212:215], v[120:135]
    ds_read_b64_tr_b16 v[218:219], v246 offset:26368
    ds_read_b128 v[204:207], v244 offset:33920
    v_exp_f32 v30, v30
    v_exp_f32 v31, v31
    v_mfma_f32_32x32x16_bf16 v[136:151], v[232:235], v[208:211], v[136:151]
    ds_read_b64_tr_b16 v[220:221], v247 offset:24832
    ds_read_b64_tr_b16 v[222:223], v247 offset:26368
    v_cvt_pk_bf16_f32 v24, v24, v25
    v_cvt_pk_bf16_f32 v25, v26, v27
    v_cvt_pk_bf16_f32 v26, v28, v29
    v_cvt_pk_bf16_f32 v27, v30, v31
    v_exp_f32 v32, v32
    v_exp_f32 v33, v33
    v_mfma_f32_32x32x16_bf16 v[48:63], v[88:91], v[24:27], v[48:63]
    s_setprio 3
    s_cmp_lg_u32 s72, 1
    s_cbranch_scc1 LF_wp1
    buffer_load_dword v242, v243, s[40:43], 0 offen
LF_wp1:
    v_exp_f32 v34, v34
    v_exp_f32 v35, v35
    v_mfma_f32_32x32x16_bf16 v[152:167], v[232:235], v[212:215], v[152:167]
    ds_read_b64_tr_b16 v[224:225], v248 offset:24832
    ds_read_b64_tr_b16 v[226:227], v248 offset:26368
    v_exp_f32 v36, v36
    v_exp_f32 v37, v37
    v_mfma_f32_32x32x16_bf16 v[168:183], v[236:239], v[208:211], v[168:183]
    v_exp_f32 v38, v38
    v_exp_f32 v39, v39
    s_waitcnt lgkmcnt(2)
    v_mfma_f32_32x32x16_bf16 v[16:31], v[80:83], v[92:95], 0
    v_cvt_pk_bf16_f32 v32, v32, v33
    v_cvt_pk_bf16_f32 v33, v34, v35
    v_cvt_pk_bf16_f32 v34, v36, v37
    v_cvt_pk_bf16_f32 v35, v38, v39
    v_mfma_f32_32x32x16_bf16 v[184:199], v[236:239], v[212:215], v[184:199]
    v_exp_f32 v40, v40
    v_exp_f32 v41, v41
    v_mfma_f32_32x32x16_bf16 v[64:79], v[84:87], v[32:35], v[64:79]
    s_setprio 2
    s_mov_b64 exec, s[28:29]
    ds_read_b128 v[84:87], v12 offset:1024
    s_mov_b64 exec, -1
    v_exp_f32 v42, v42
    v_exp_f32 v43, v43
    v_mfma_f32_32x32x16_bf16 v[104:119], v[216:219], v[200:203], v[104:119]
    ds_read_b128 v[208:211], v244 offset:672
    ds_read_b64_tr_b16 v[228:229], v246 offset:30976
    v_exp_f32 v44, v44
    v_exp_f32 v45, v45
    v_mfma_f32_32x32x16_bf16 v[120:135], v[216:219], v[204:207], v[120:135]
    ds_read_b64_tr_b16 v[230:231], v246 offset:32512
    ds_read_b128 v[212:215], v244 offset:33952
    v_exp_f32 v46, v46
    v_exp_f32 v47, v47
    v_mfma_f32_32x32x16_bf16 v[136:151], v[220:223], v[200:203], v[136:151]
    ds_read_b64_tr_b16 v[232:233], v247 offset:30976
    ds_read_b64_tr_b16 v[234:235], v247 offset:32512
    v_cvt_pk_bf16_f32 v40, v40, v41
    v_cvt_pk_bf16_f32 v41, v42, v43
    v_cvt_pk_bf16_f32 v42, v44, v45
    v_cvt_pk_bf16_f32 v43, v46, v47
    v_exp_f32 v16, v16
    v_exp_f32 v17, v17
    v_mfma_f32_32x32x16_bf16 v[64:79], v[88:91], v[40:43], v[64:79]
    s_mov_b64 exec, s[28:29]
    ds_read_b128 v[88:91], v12 offset:1536
    s_mov_b64 exec, -1
    s_setprio 1
    v_exp_f32 v18, v18
    v_exp_f32 v19, v19
    v_mfma_f32_32x32x16_bf16 v[152:167], v[220:223], v[204:207], v[152:167]
    ds_read_b64_tr_b16 v[236:237], v248 offset:30976
    ds_read_b64_tr_b16 v[238:239], v248 offset:32512
    v_exp_f32 v20, v20
    v_exp_f32 v21, v21
    s_waitcnt lgkmcnt(2)
    v_mfma_f32_32x32x16_bf16 v[168:183], v[224:227], v[200:203], v[168:183]
    v_exp_f32 v22, v22
    v_exp_f32 v23, v23
    v_mfma_f32_32x32x16_bf16 v[32:47], v[80:83], v[96:99], 0
    v_cvt_pk_bf16_f32 v16, v16, v17
    v_cvt_pk_bf16_f32 v17, v18, v19
    v_cvt_pk_bf16_f32 v18, v20, v21
    v_cvt_pk_bf16_f32 v19, v22, v23
    v_exp_f32 v24, v24
    v_exp_f32 v25, v25
    v_mfma_f32_32x32x16_bf16 v[48:63], v[84:87], v[16:19], v[48:63]
    v_mfma_f32_32x32x16_bf16 v[184:199], v[224:227], v[204:207], v[184:199]
    s_waitcnt lgkmcnt(0)
    s_barrier
    s_setprio 3
    ds_read_b128 v[80:83], v11 offset:8192
    v_exp_f32 v26, v26
    v_exp_f32 v27, v27
    v_mfma_f32_32x32x16_bf16 v[104:119], v[228:231], v[208:211], v[104:119]
    ds_read_b128 v[200:203], v244 offset:704
    ds_read_b64_tr_b16 v[216:217], v246 offset:49664
    v_exp_f32 v28, v28
    v_exp_f32 v29, v29
    v_mfma_f32_32x32x16_bf16 v[120:135], v[228:231], v[212:215], v[120:135]
    ds_read_b64_tr_b16 v[218:219], v246 offset:51200
    ds_read_b128 v[204:207], v244 offset:33984
    v_exp_f32 v30, v30
    v_exp_f32 v31, v31
    v_mfma_f32_32x32x16_bf16 v[136:151], v[232:235], v[208:211], v[136:151]
    ds_read_b64_tr_b16 v[220:221], v247 offset:49664
    ds_read_b64_tr_b16 v[222:223], v247 offset:51200
    v_cvt_pk_bf16_f32 v24, v24, v25
    v_cvt_pk_bf16_f32 v25, v26, v27
    v_cvt_pk_bf16_f32 v26, v28, v29
    v_cvt_pk_bf16_f32 v27, v30, v31
    v_exp_f32 v32, v32
    v_exp_f32 v33, v33
    v_mfma_f32_32x32x16_bf16 v[48:63], v[88:91], v[24:27], v[48:63]
    s_setprio 3
    s_cmp_lg_u32 s72, 2
    s_cbranch_scc1 LF_wp2
    buffer_load_dword v242, v243, s[40:43], 0 offen
LF_wp2:
    v_exp_f32 v34, v34
    v_exp_f32 v35, v35
    v_mfma_f32_32x32x16_bf16 v[152:167], v[232:235], v[212:215], v[152:167]
    ds_read_b64_tr_b16 v[224:225], v248 offset:49664
    ds_read_b64_tr_b16 v[226:227], v248 offset:51200
    v_exp_f32 v36, v36
    v_exp_f32 v37, v37
    v_mfma_f32_32x32x16_bf16 v[168:183], v[236:239], v[208:211], v[168:183]
    v_exp_f32 v38, v38
    v_exp_f32 v39, v39
    s_waitcnt lgkmcnt(2)
    v_mfma_f32_32x32x16_bf16 v[16:31], v[80:83], v[92:95], 0
    v_cvt_pk_bf16_f32 v32, v32, v33
    v_cvt_pk_bf16_f32 v33, v34, v35
    v_cvt_pk_bf16_f32 v34, v36, v37
    v_cvt_pk_bf16_f32 v35, v38, v39
    v_mfma_f32_32x32x16_bf16 v[184:199], v[236:239], v[212:215], v[184:199]
    v_exp_f32 v40, v40
    v_exp_f32 v41, v41
    v_mfma_f32_32x32x16_bf16 v[64:79], v[84:87], v[32:35], v[64:79]
    s_setprio 2
    s_mov_b64 exec, s[28:29]
    ds_read_b128 v[84:87], v13 offset:0
    s_mov_b64 exec, -1
    v_exp_f32 v42, v42
    v_exp_f32 v43, v43
    v_mfma_f32_32x32x16_bf16 v[104:119], v[216:219], v[200:203], v[104:119]
    ds_read_b128 v[208:211], v244 offset:736
    ds_read_b64_tr_b16 v[228:229], v246 offset:55808
    v_exp_f32 v44, v44
    v_exp_f32 v45, v45
    v_mfma_f32_32x32x16_bf16 v[120:135], v[216:219], v[204:207], v[120:135]
    ds_read_b64_tr_b16 v[230:231], v246 offset:57344
    ds_read_b128 v[212:215], v244 offset:34016
    v_exp_f32 v46, v46
    v_exp_f32 v47, v47
    v_mfma_f32_32x32x16_bf16 v[136:151], v[220:223], v[200:203], v[136:151]
    ds_read_b64_tr_b16 v[232:233], v247 offset:55808
    ds_read_b64_tr_b16 v[234:235], v247 offset:57344
    v_cvt_pk_bf16_f32 v40, v40, v41
    v_cvt_pk_bf16_f32 v41, v42, v43
    v_cvt_pk_bf16_f32 v42, v44, v45
    v_cvt_pk_bf16_f32 v43, v46, v47
    v_exp_f32 v16, v16
    v_exp_f32 v17, v17
    v_mfma_f32_32x32x16_bf16 v[64:79], v[88:91], v[40:43], v[64:79]
    s_mov_b64 exec, s[28:29]
    ds_read_b128 v[88:91], v13 offset:512
    s_mov_b64 exec, -1
    s_setprio 1
    v_exp_f32 v18, v18
    v_exp_f32 v19, v19
    v_mfma_f32_32x32x16_bf16 v[152:167], v[220:223], v[204:207], v[152:167]
    ds_read_b64_tr_b16 v[236:237], v248 offset:55808
    ds_read_b64_tr_b16 v[238:239], v248 offset:57344
    v_exp_f32 v20, v20
    v_exp_f32 v21, v21
    s_waitcnt lgkmcnt(2)
    v_mfma_f32_32x32x16_bf16 v[168:183], v[224:227], v[200:203], v[168:183]
    v_exp_f32 v22, v22
    v_exp_f32 v23, v23
    v_mfma_f32_32x32x16_bf16 v[32:47], v[80:83], v[96:99], 0
    v_cvt_pk_bf16_f32 v16, v16, v17
    v_cvt_pk_bf16_f32 v17, v18, v19
    v_cvt_pk_bf16_f32 v18, v20, v21
    v_cvt_pk_bf16_f32 v19, v22, v23
    v_exp_f32 v24, v24
    v_exp_f32 v25, v25
    v_mfma_f32_32x32x16_bf16 v[48:63], v[84:87], v[16:19], v[48:63]
    v_mfma_f32_32x32x16_bf16 v[184:199], v[224:227], v[204:207], v[184:199]
    s_waitcnt lgkmcnt(0)
    s_barrier
    s_setprio 3
    ds_read_b128 v[80:83], v11 offset:9216
    v_exp_f32 v26, v26
    v_exp_f32 v27, v27
    v_mfma_f32_32x32x16_bf16 v[104:119], v[228:231], v[208:211], v[104:119]
    ds_read_b128 v[200:203], v244 offset:768
    ds_read_b64_tr_b16 v[216:217], v246 offset:0
    v_exp_f32 v28, v28
    v_exp_f32 v29, v29
    v_mfma_f32_32x32x16_bf16 v[120:135], v[228:231], v[212:215], v[120:135]
    ds_read_b64_tr_b16 v[218:219], v246 offset:1536
    ds_read_b128 v[204:207], v244 offset:34048
    v_exp_f32 v30, v30
    v_exp_f32 v31, v31
    v_mfma_f32_32x32x16_bf16 v[136:151], v[232:235], v[208:211], v[136:151]
    ds_read_b64_tr_b16 v[220:221], v247 offset:0
    ds_read_b64_tr_b16 v[222:223], v247 offset:1536
    v_cvt_pk_bf16_f32 v24, v24, v25
    v_cvt_pk_bf16_f32 v25, v26, v27
    v_cvt_pk_bf16_f32 v26, v28, v29
    v_cvt_pk_bf16_f32 v27, v30, v31
    v_exp_f32 v32, v32
    v_exp_f32 v33, v33
    v_mfma_f32_32x32x16_bf16 v[48:63], v[88:91], v[24:27], v[48:63]
    s_setprio 3
    s_cmp_lg_u32 s72, 3
    s_cbranch_scc1 LF_wp3
    buffer_load_dword v242, v243, s[40:43], 0 offen
LF_wp3:
    v_exp_f32 v34, v34
    v_exp_f32 v35, v35
    v_mfma_f32_32x32x16_bf16 v[152:167], v[232:235], v[212:215], v[152:167]
    ds_read_b64_tr_b16 v[224:225], v248 offset:0
    ds_read_b64_tr_b16 v[226:227], v248 offset:1536
    v_exp_f32 v36, v36
    v_exp_f32 v37, v37
    v_mfma_f32_32x32x16_bf16 v[168:183], v[236:239], v[208:211], v[168:183]
    v_exp_f32 v38, v38
    v_exp_f32 v39, v39
    s_waitcnt lgkmcnt(2)
    v_mfma_f32_32x32x16_bf16 v[16:31], v[80:83], v[92:95], 0
    v_cvt_pk_bf16_f32 v32, v32, v33
    v_cvt_pk_bf16_f32 v33, v34, v35
    v_cvt_pk_bf16_f32 v34, v36, v37
    v_cvt_pk_bf16_f32 v35, v38, v39
    v_mfma_f32_32x32x16_bf16 v[184:199], v[236:239], v[212:215], v[184:199]
    v_exp_f32 v40, v40
    v_exp_f32 v41, v41
    v_mfma_f32_32x32x16_bf16 v[64:79], v[84:87], v[32:35], v[64:79]
    s_setprio 2
    s_mov_b64 exec, s[28:29]
    ds_read_b128 v[84:87], v13 offset:1024
    s_mov_b64 exec, -1
    v_exp_f32 v42, v42
    v_exp_f32 v43, v43
    v_mfma_f32_32x32x16_bf16 v[104:119], v[216:219], v[200:203], v[104:119]
    ds_read_b128 v[208:211], v244 offset:800
    ds_read_b64_tr_b16 v[228:229], v246 offset:6144
    v_exp_f32 v44, v44
    v_exp_f32 v45, v45
    v_mfma_f32_32x32x16_bf16 v[120:135], v[216:219], v[204:207], v[120:135]
    ds_read_b64_tr_b16 v[230:231], v246 offset:7680
    ds_read_b128 v[212:215], v244 offset:34080
    v_exp_f32 v46, v46
    v_exp_f32 v47, v47
    v_mfma_f32_32x32x16_bf16 v[136:151], v[220:223], v[200:203], v[136:151]
    ds_read_b64_tr_b16 v[232:233], v247 offset:6144
    ds_read_b64_tr_b16 v[234:235], v247 offset:7680
    v_cvt_pk_bf16_f32 v40, v40, v41
    v_cvt_pk_bf16_f32 v41, v42, v43
    v_cvt_pk_bf16_f32 v42, v44, v45
    v_cvt_pk_bf16_f32 v43, v46, v47
    v_exp_f32 v16, v16
    v_exp_f32 v17, v17
    v_mfma_f32_32x32x16_bf16 v[64:79], v[88:91], v[40:43], v[64:79]
    s_mov_b64 exec, s[28:29]
    ds_read_b128 v[88:91], v13 offset:1536
    s_mov_b64 exec, -1
    s_setprio 1
    v_exp_f32 v18, v18
    v_exp_f32 v19, v19
    v_mfma_f32_32x32x16_bf16 v[152:167], v[220:223], v[204:207], v[152:167]
    ds_read_b64_tr_b16 v[236:237], v248 offset:6144
    ds_read_b64_tr_b16 v[238:239], v248 offset:7680
    v_exp_f32 v20, v20
    v_exp_f32 v21, v21
    s_waitcnt lgkmcnt(2)
    v_mfma_f32_32x32x16_bf16 v[168:183], v[224:227], v[200:203], v[168:183]
    v_exp_f32 v22, v22
    v_exp_f32 v23, v23
    v_mfma_f32_32x32x16_bf16 v[32:47], v[80:83], v[96:99], 0
    v_cvt_pk_bf16_f32 v16, v16, v17
    v_cvt_pk_bf16_f32 v17, v18, v19
    v_cvt_pk_bf16_f32 v18, v20, v21
    v_cvt_pk_bf16_f32 v19, v22, v23
    v_exp_f32 v24, v24
    v_exp_f32 v25, v25
    v_mfma_f32_32x32x16_bf16 v[48:63], v[84:87], v[16:19], v[48:63]
    v_mfma_f32_32x32x16_bf16 v[184:199], v[224:227], v[204:207], v[184:199]
    s_waitcnt lgkmcnt(0)
    s_barrier
    s_setprio 3
    ds_read_b128 v[80:83], v11 offset:0
    v_exp_f32 v26, v26
    v_exp_f32 v27, v27
    v_mfma_f32_32x32x16_bf16 v[104:119], v[228:231], v[208:211], v[104:119]
    ds_read_b128 v[200:203], v244 offset:832
    ds_read_b64_tr_b16 v[216:217], v246 offset:24832
    v_exp_f32 v28, v28
    v_exp_f32 v29, v29
    v_mfma_f32_32x32x16_bf16 v[120:135], v[228:231], v[212:215], v[120:135]
    ds_read_b64_tr_b16 v[218:219], v246 offset:26368
    ds_read_b128 v[204:207], v244 offset:34112
    v_exp_f32 v30, v30
    v_exp_f32 v31, v31
    v_mfma_f32_32x32x16_bf16 v[136:151], v[232:235], v[208:211], v[136:151]
    ds_read_b64_tr_b16 v[220:221], v247 offset:24832
    ds_read_b64_tr_b16 v[222:223], v247 offset:26368
    v_cvt_pk_bf16_f32 v24, v24, v25
    v_cvt_pk_bf16_f32 v25, v26, v27
    v_cvt_pk_bf16_f32 v26, v28, v29
    v_cvt_pk_bf16_f32 v27, v30, v31
    v_exp_f32 v32, v32
    v_exp_f32 v33, v33
    v_mfma_f32_32x32x16_bf16 v[48:63], v[88:91], v[24:27], v[48:63]
    s_setprio 3
    v_exp_f32 v34, v34
    v_exp_f32 v35, v35
    v_mfma_f32_32x32x16_bf16 v[152:167], v[232:235], v[212:215], v[152:167]
    ds_read_b64_tr_b16 v[224:225], v248 offset:24832
    ds_read_b64_tr_b16 v[226:227], v248 offset:26368
    v_exp_f32 v36, v36
    v_exp_f32 v37, v37
    v_mfma_f32_32x32x16_bf16 v[168:183], v[236:239], v[208:211], v[168:183]
    v_exp_f32 v38, v38
    v_exp_f32 v39, v39
    s_waitcnt lgkmcnt(2)
    v_mfma_f32_32x32x16_bf16 v[16:31], v[80:83], v[92:95], 0
    v_cvt_pk_bf16_f32 v32, v32, v33
    v_cvt_pk_bf16_f32 v33, v34, v35
    v_cvt_pk_bf16_f32 v34, v36, v37
    v_cvt_pk_bf16_f32 v35, v38, v39
    v_mfma_f32_32x32x16_bf16 v[184:199], v[236:239], v[212:215], v[184:199]
    v_exp_f32 v40, v40
    v_exp_f32 v41, v41
    v_mfma_f32_32x32x16_bf16 v[64:79], v[84:87], v[32:35], v[64:79]
    s_setprio 2
    s_mov_b64 exec, s[28:29]
    ds_read_b128 v[84:87], v12 offset:0
    s_mov_b64 exec, -1
    v_exp_f32 v42, v42
    v_exp_f32 v43, v43
    v_mfma_f32_32x32x16_bf16 v[104:119], v[216:219], v[200:203], v[104:119]
    ds_read_b128 v[208:211], v244 offset:864
    ds_read_b64_tr_b16 v[228:229], v246 offset:30976
    v_exp_f32 v44, v44
    v_exp_f32 v45, v45
    v_mfma_f32_32x32x16_bf16 v[120:135], v[216:219], v[204:207], v[120:135]
    ds_read_b64_tr_b16 v[230:231], v246 offset:32512
    ds_read_b128 v[212:215], v244 offset:34144
    v_exp_f32 v46, v46
    v_exp_f32 v47, v47
    v_mfma_f32_32x32x16_bf16 v[136:151], v[220:223], v[200:203], v[136:151]
    ds_read_b64_tr_b16 v[232:233], v247 offset:30976
    ds_read_b64_tr_b16 v[234:235], v247 offset:32512
    v_cvt_pk_bf16_f32 v40, v40, v41
    v_cvt_pk_bf16_f32 v41, v42, v43
    v_cvt_pk_bf16_f32 v42, v44, v45
    v_cvt_pk_bf16_f32 v43, v46, v47
    v_exp_f32 v16, v16
    v_exp_f32 v17, v17
    v_mfma_f32_32x32x16_bf16 v[64:79], v[88:91], v[40:43], v[64:79]
    s_mov_b64 exec, s[28:29]
    ds_read_b128 v[88:91], v12 offset:512
    s_mov_b64 exec, -1
    s_setprio 1
    v_exp_f32 v18, v18
    v_exp_f32 v19, v19
    v_mfma_f32_32x32x16_bf16 v[152:167], v[220:223], v[204:207], v[152:167]
    ds_read_b64_tr_b16 v[236:237], v248 offset:30976
    ds_read_b64_tr_b16 v[238:239], v248 offset:32512
    v_exp_f32 v20, v20
    v_exp_f32 v21, v21
    s_waitcnt lgkmcnt(2)
    v_mfma_f32_32x32x16_bf16 v[168:183], v[224:227], v[200:203], v[168:183]
    v_exp_f32 v22, v22
    v_exp_f32 v23, v23
    v_mfma_f32_32x32x16_bf16 v[32:47], v[80:83], v[96:99], 0
    v_cvt_pk_bf16_f32 v16, v16, v17
    v_cvt_pk_bf16_f32 v17, v18, v19
    v_cvt_pk_bf16_f32 v18, v20, v21
    v_cvt_pk_bf16_f32 v19, v22, v23
    v_exp_f32 v24, v24
    v_exp_f32 v25, v25
    v_mfma_f32_32x32x16_bf16 v[48:63], v[84:87], v[16:19], v[48:63]
    v_mfma_f32_32x32x16_bf16 v[184:199], v[224:227], v[204:207], v[184:199]
    s_waitcnt lgkmcnt(0)
    s_barrier
    s_setprio 3
    ds_read_b128 v[80:83], v11 offset:1024
    v_exp_f32 v26, v26
    v_exp_f32 v27, v27
    v_mfma_f32_32x32x16_bf16 v[104:119], v[228:231], v[208:211], v[104:119]
    ds_read_b128 v[200:203], v244 offset:896
    ds_read_b64_tr_b16 v[216:217], v246 offset:49664
    v_exp_f32 v28, v28
    v_exp_f32 v29, v29
    v_mfma_f32_32x32x16_bf16 v[120:135], v[228:231], v[212:215], v[120:135]
    ds_read_b64_tr_b16 v[218:219], v246 offset:51200
    ds_read_b128 v[204:207], v244 offset:34176
    v_exp_f32 v30, v30
    v_exp_f32 v31, v31
    v_mfma_f32_32x32x16_bf16 v[136:151], v[232:235], v[208:211], v[136:151]
    ds_read_b64_tr_b16 v[220:221], v247 offset:49664
    ds_read_b64_tr_b16 v[222:223], v247 offset:51200
    v_cvt_pk_bf16_f32 v24, v24, v25
    v_cvt_pk_bf16_f32 v25, v26, v27
    v_cvt_pk_bf16_f32 v26, v28, v29
    v_cvt_pk_bf16_f32 v27, v30, v31
    v_exp_f32 v32, v32
    v_exp_f32 v33, v33
    v_mfma_f32_32x32x16_bf16 v[48:63], v[88:91], v[24:27], v[48:63]
    s_setprio 3
    v_exp_f32 v34, v34
    v_exp_f32 v35, v35
    v_mfma_f32_32x32x16_bf16 v[152:167], v[232:235], v[212:215], v[152:167]
    ds_read_b64_tr_b16 v[224:225], v248 offset:49664
    ds_read_b64_tr_b16 v[226:227], v248 offset:51200
    v_exp_f32 v36, v36
    v_exp_f32 v37, v37
    v_mfma_f32_32x32x16_bf16 v[168:183], v[236:239], v[208:211], v[168:183]
    v_exp_f32 v38, v38
    v_exp_f32 v39, v39
    s_waitcnt lgkmcnt(2)
    v_mfma_f32_32x32x16_bf16 v[16:31], v[80:83], v[92:95], 0
    v_cvt_pk_bf16_f32 v32, v32, v33
    v_cvt_pk_bf16_f32 v33, v34, v35
    v_cvt_pk_bf16_f32 v34, v36, v37
    v_cvt_pk_bf16_f32 v35, v38, v39
    v_mfma_f32_32x32x16_bf16 v[184:199], v[236:239], v[212:215], v[184:199]
    v_exp_f32 v40, v40
    v_exp_f32 v41, v41
    v_mfma_f32_32x32x16_bf16 v[64:79], v[84:87], v[32:35], v[64:79]
    s_setprio 2
    s_mov_b64 exec, s[28:29]
    ds_read_b128 v[84:87], v12 offset:1024
    s_mov_b64 exec, -1
    v_exp_f32 v42, v42
    v_exp_f32 v43, v43
    v_mfma_f32_32x32x16_bf16 v[104:119], v[216:219], v[200:203], v[104:119]
    ds_read_b128 v[208:211], v244 offset:928
    ds_read_b64_tr_b16 v[228:229], v246 offset:55808
    v_exp_f32 v44, v44
    v_exp_f32 v45, v45
    v_mfma_f32_32x32x16_bf16 v[120:135], v[216:219], v[204:207], v[120:135]
    ds_read_b64_tr_b16 v[230:231], v246 offset:57344
    ds_read_b128 v[212:215], v244 offset:34208
    v_exp_f32 v46, v46
    v_exp_f32 v47, v47
    v_mfma_f32_32x32x16_bf16 v[136:151], v[220:223], v[200:203], v[136:151]
    ds_read_b64_tr_b16 v[232:233], v247 offset:55808
    ds_read_b64_tr_b16 v[234:235], v247 offset:57344
    v_cvt_pk_bf16_f32 v40, v40, v41
    v_cvt_pk_bf16_f32 v41, v42, v43
    v_cvt_pk_bf16_f32 v42, v44, v45
    v_cvt_pk_bf16_f32 v43, v46, v47
    v_exp_f32 v16, v16
    v_exp_f32 v17, v17
    v_mfma_f32_32x32x16_bf16 v[64:79], v[88:91], v[40:43], v[64:79]
    s_mov_b64 exec, s[28:29]
    ds_read_b128 v[88:91], v12 offset:1536
    s_mov_b64 exec, -1
    s_setprio 1
    v_exp_f32 v18, v18
    v_exp_f32 v19, v19
    v_mfma_f32_32x32x16_bf16 v[152:167], v[220:223], v[204:207], v[152:167]
    ds_read_b64_tr_b16 v[236:237], v248 offset:55808
    ds_read_b64_tr_b16 v[238:239], v248 offset:57344
    v_exp_f32 v20, v20
    v_exp_f32 v21, v21
    s_waitcnt lgkmcnt(2)
    v_mfma_f32_32x32x16_bf16 v[168:183], v[224:227], v[200:203], v[168:183]
    v_exp_f32 v22, v22
    v_exp_f32 v23, v23
    v_mfma_f32_32x32x16_bf16 v[32:47], v[80:83], v[96:99], 0
    v_cvt_pk_bf16_f32 v16, v16, v17
    v_cvt_pk_bf16_f32 v17, v18, v19
    v_cvt_pk_bf16_f32 v18, v20, v21
    v_cvt_pk_bf16_f32 v19, v22, v23
    v_exp_f32 v24, v24
    v_exp_f32 v25, v25
    v_mfma_f32_32x32x16_bf16 v[48:63], v[84:87], v[16:19], v[48:63]
    v_mfma_f32_32x32x16_bf16 v[184:199], v[224:227], v[204:207], v[184:199]
    s_waitcnt lgkmcnt(0)
    s_barrier
    s_setprio 3
    ds_read_b128 v[80:83], v11 offset:8192
    v_exp_f32 v26, v26
    v_exp_f32 v27, v27
    v_mfma_f32_32x32x16_bf16 v[104:119], v[228:231], v[208:211], v[104:119]
    ds_read_b128 v[200:203], v244 offset:960
    ds_read_b64_tr_b16 v[216:217], v246 offset:0
    v_exp_f32 v28, v28
    v_exp_f32 v29, v29
    v_mfma_f32_32x32x16_bf16 v[120:135], v[228:231], v[212:215], v[120:135]
    ds_read_b64_tr_b16 v[218:219], v246 offset:1536
    ds_read_b128 v[204:207], v244 offset:34240
    v_exp_f32 v30, v30
    v_exp_f32 v31, v31
    v_mfma_f32_32x32x16_bf16 v[136:151], v[232:235], v[208:211], v[136:151]
    ds_read_b64_tr_b16 v[220:221], v247 offset:0
    ds_read_b64_tr_b16 v[222:223], v247 offset:1536
    v_cvt_pk_bf16_f32 v24, v24, v25
    v_cvt_pk_bf16_f32 v25, v26, v27
    v_cvt_pk_bf16_f32 v26, v28, v29
    v_cvt_pk_bf16_f32 v27, v30, v31
    v_exp_f32 v32, v32
    v_exp_f32 v33, v33
    v_mfma_f32_32x32x16_bf16 v[48:63], v[88:91], v[24:27], v[48:63]
    s_setprio 3
    v_exp_f32 v34, v34
    v_exp_f32 v35, v35
    v_mfma_f32_32x32x16_bf16 v[152:167], v[232:235], v[212:215], v[152:167]
    ds_read_b64_tr_b16 v[224:225], v248 offset:0
    ds_read_b64_tr_b16 v[226:227], v248 offset:1536
    v_exp_f32 v36, v36
    v_exp_f32 v37, v37
    v_mfma_f32_32x32x16_bf16 v[168:183], v[236:239], v[208:211], v[168:183]
    v_exp_f32 v38, v38
    v_exp_f32 v39, v39
    s_waitcnt lgkmcnt(2)
    v_mfma_f32_32x32x16_bf16 v[16:31], v[80:83], v[92:95], 0
    v_cvt_pk_bf16_f32 v32, v32, v33
    v_cvt_pk_bf16_f32 v33, v34, v35
    v_cvt_pk_bf16_f32 v34, v36, v37
    v_cvt_pk_bf16_f32 v35, v38, v39
    v_mfma_f32_32x32x16_bf16 v[184:199], v[236:239], v[212:215], v[184:199]
    v_exp_f32 v40, v40
    v_exp_f32 v41, v41
    v_mfma_f32_32x32x16_bf16 v[64:79], v[84:87], v[32:35], v[64:79]
    s_setprio 2
    s_mov_b64 exec, s[28:29]
    ds_read_b128 v[84:87], v13 offset:0
    s_mov_b64 exec, -1
    v_exp_f32 v42, v42
    v_exp_f32 v43, v43
    v_mfma_f32_32x32x16_bf16 v[104:119], v[216:219], v[200:203], v[104:119]
    ds_read_b128 v[208:211], v244 offset:992
    ds_read_b64_tr_b16 v[228:229], v246 offset:6144
    v_exp_f32 v44, v44
    v_exp_f32 v45, v45
    v_mfma_f32_32x32x16_bf16 v[120:135], v[216:219], v[204:207], v[120:135]
    ds_read_b64_tr_b16 v[230:231], v246 offset:7680
    ds_read_b128 v[212:215], v244 offset:34272
    v_exp_f32 v46, v46
    v_exp_f32 v47, v47
    v_mfma_f32_32x32x16_bf16 v[136:151], v[220:223], v[200:203], v[136:151]
    ds_read_b64_tr_b16 v[232:233], v247 offset:6144
    ds_read_b64_tr_b16 v[234:235], v247 offset:7680
    v_cvt_pk_bf16_f32 v40, v40, v41
    v_cvt_pk_bf16_f32 v41, v42, v43
    v_cvt_pk_bf16_f32 v42, v44, v45
    v_cvt_pk_bf16_f32 v43, v46, v47
    v_exp_f32 v16, v16
    v_exp_f32 v17, v17
    v_mfma_f32_32x32x16_bf16 v[64:79], v[88:91], v[40:43], v[64:79]
    s_mov_b64 exec, s[28:29]
    ds_read_b128 v[88:91], v13 offset:512
    s_mov_b64 exec, -1
    s_setprio 1
    v_exp_f32 v18, v18
    v_exp_f32 v19, v19
    v_mfma_f32_32x32x16_bf16 v[152:167], v[220:223], v[204:207], v[152:167]
    ds_read_b64_tr_b16 v[236:237], v248 offset:6144
    ds_read_b64_tr_b16 v[238:239], v248 offset:7680
    v_exp_f32 v20, v20
    v_exp_f32 v21, v21
    s_waitcnt lgkmcnt(2)
    v_mfma_f32_32x32x16_bf16 v[168:183], v[224:227], v[200:203], v[168:183]
    v_exp_f32 v22, v22
    v_exp_f32 v23, v23
    v_mfma_f32_32x32x16_bf16 v[32:47], v[80:83], v[96:99], 0
    v_cvt_pk_bf16_f32 v16, v16, v17
    v_cvt_pk_bf16_f32 v17, v18, v19
    v_cvt_pk_bf16_f32 v18, v20, v21
    v_cvt_pk_bf16_f32 v19, v22, v23
    v_exp_f32 v24, v24
    v_exp_f32 v25, v25
    v_mfma_f32_32x32x16_bf16 v[48:63], v[84:87], v[16:19], v[48:63]
    v_mfma_f32_32x32x16_bf16 v[184:199], v[224:227], v[204:207], v[184:199]
    s_waitcnt lgkmcnt(0)
    s_barrier
    s_setprio 3
    ds_read_b128 v[80:83], v11 offset:9216
    v_exp_f32 v26, v26
    v_exp_f32 v27, v27
    v_mfma_f32_32x32x16_bf16 v[104:119], v[228:231], v[208:211], v[104:119]
    v_exp_f32 v28, v28
    v_exp_f32 v29, v29
    v_mfma_f32_32x32x16_bf16 v[120:135], v[228:231], v[212:215], v[120:135]
    v_exp_f32 v30, v30
    v_exp_f32 v31, v31
    v_mfma_f32_32x32x16_bf16 v[136:151], v[232:235], v[208:211], v[136:151]
    v_cvt_pk_bf16_f32 v24, v24, v25
    v_cvt_pk_bf16_f32 v25, v26, v27
    v_cvt_pk_bf16_f32 v26, v28, v29
    v_cvt_pk_bf16_f32 v27, v30, v31
    v_exp_f32 v32, v32
    v_exp_f32 v33, v33
    v_mfma_f32_32x32x16_bf16 v[48:63], v[88:91], v[24:27], v[48:63]
    s_setprio 3
    v_exp_f32 v34, v34
    v_exp_f32 v35, v35
    v_mfma_f32_32x32x16_bf16 v[152:167], v[232:235], v[212:215], v[152:167]
    v_exp_f32 v36, v36
    v_exp_f32 v37, v37
    v_mfma_f32_32x32x16_bf16 v[168:183], v[236:239], v[208:211], v[168:183]
    v_exp_f32 v38, v38
    v_exp_f32 v39, v39
    s_waitcnt lgkmcnt(0)
    v_mfma_f32_32x32x16_bf16 v[16:31], v[80:83], v[92:95], 0
    v_cvt_pk_bf16_f32 v32, v32, v33
    v_cvt_pk_bf16_f32 v33, v34, v35
    v_cvt_pk_bf16_f32 v34, v36, v37
    v_cvt_pk_bf16_f32 v35, v38, v39
    v_mfma_f32_32x32x16_bf16 v[184:199], v[236:239], v[212:215], v[184:199]
    v_exp_f32 v40, v40
    v_exp_f32 v41, v41
    v_mfma_f32_32x32x16_bf16 v[64:79], v[84:87], v[32:35], v[64:79]
    s_setprio 3
    s_mov_b64 exec, s[28:29]
    ds_read_b128 v[84:87], v13 offset:1024
    s_mov_b64 exec, -1
    v_exp_f32 v42, v42
    v_exp_f32 v43, v43
    v_mov_b32 v208, 0xc0135761
    v_mov_b32 v209, 0xc0135761
    v_mov_b32 v210, 0xbdd2d3e8
    v_mov_b32 v211, 0xbdd2d3e8
    v_pk_mul_f32 v[200:201], v[104:105], v[104:105]
    v_pk_mul_f32 v[202:203], v[106:107], v[106:107]
    v_pk_mul_f32 v[204:205], v[108:109], v[108:109]
    v_pk_mul_f32 v[206:207], v[110:111], v[110:111]
    v_pk_fma_f32 v[200:201], v[200:201], v[210:211], v[208:209]
    v_pk_fma_f32 v[202:203], v[202:203], v[210:211], v[208:209]
    v_pk_fma_f32 v[204:205], v[204:205], v[210:211], v[208:209]
    v_pk_fma_f32 v[206:207], v[206:207], v[210:211], v[208:209]
    v_pk_mul_f32 v[200:201], v[200:201], v[104:105]
    v_pk_mul_f32 v[202:203], v[202:203], v[106:107]
    v_pk_mul_f32 v[204:205], v[204:205], v[108:109]
    v_pk_mul_f32 v[206:207], v[206:207], v[110:111]
    v_exp_f32 v200, v200
    v_exp_f32 v201, v201
    v_exp_f32 v202, v202
    v_exp_f32 v44, v44
    v_exp_f32 v45, v45
    v_exp_f32 v203, v203
    v_exp_f32 v204, v204
    v_exp_f32 v205, v205
    v_exp_f32 v206, v206
    v_exp_f32 v207, v207
    v_pk_mul_f32 v[112:113], v[112:113], v[104:105]
    v_pk_mul_f32 v[114:115], v[114:115], v[106:107]
    v_pk_mul_f32 v[116:117], v[116:117], v[108:109]
    v_pk_mul_f32 v[118:119], v[118:119], v[110:111]
    v_pk_add_f32 v[200:201], v[200:201], 1.0 op_sel_hi:[1,0]
    v_pk_add_f32 v[202:203], v[202:203], 1.0 op_sel_hi:[1,0]
    v_pk_add_f32 v[204:205], v[204:205], 1.0 op_sel_hi:[1,0]
    v_pk_add_f32 v[206:207], v[206:207], 1.0 op_sel_hi:[1,0]
    v_rcp_f32 v200, v200
    v_rcp_f32 v201, v201
    v_rcp_f32 v202, v202
    v_rcp_f32 v203, v203
    v_rcp_f32 v204, v204
    v_rcp_f32 v205, v205
    v_exp_f32 v46, v46
    v_exp_f32 v47, v47
    v_rcp_f32 v206, v206
    v_rcp_f32 v207, v207
    v_pk_mul_f32 v[200:201], v[200:201], v[112:113]
    v_pk_mul_f32 v[202:203], v[202:203], v[114:115]
    v_pk_mul_f32 v[204:205], v[204:205], v[116:117]
    v_pk_mul_f32 v[206:207], v[206:207], v[118:119]
    v_cvt_pk_bf16_f32 v216, v200, v201
    v_cvt_pk_bf16_f32 v217, v202, v203
    v_cvt_pk_bf16_f32 v218, v204, v205
    v_cvt_pk_bf16_f32 v219, v206, v207
    buffer_store_dwordx4 v[216:219], v3, s[52:55], s4 offen sc1
    v_pk_mul_f32 v[200:201], v[120:121], v[120:121]
    v_pk_mul_f32 v[202:203], v[122:123], v[122:123]
    v_pk_mul_f32 v[204:205], v[124:125], v[124:125]
    v_pk_mul_f32 v[206:207], v[126:127], v[126:127]
    v_pk_fma_f32 v[200:201], v[200:201], v[210:211], v[208:209]
    v_pk_fma_f32 v[202:203], v[202:203], v[210:211], v[208:209]
    v_pk_fma_f32 v[204:205], v[204:205], v[210:211], v[208:209]
    v_pk_fma_f32 v[206:207], v[206:207], v[210:211], v[208:209]
    v_cvt_pk_bf16_f32 v40, v40, v41
    v_cvt_pk_bf16_f32 v41, v42, v43
    v_cvt_pk_bf16_f32 v42, v44, v45
    v_cvt_pk_bf16_f32 v43, v46, v47
    v_exp_f32 v16, v16
    v_exp_f32 v17, v17
    v_mfma_f32_32x32x16_bf16 v[64:79], v[88:91], v[40:43], v[64:79]
    s_mov_b64 exec, s[28:29]
    ds_read_b128 v[88:91], v13 offset:1536
    s_mov_b64 exec, -1
    v_exp_f32 v18, v18
    v_exp_f32 v19, v19
    v_pk_mul_f32 v[200:201], v[200:201], v[120:121]
    v_pk_mul_f32 v[202:203], v[202:203], v[122:123]
    v_pk_mul_f32 v[204:205], v[204:205], v[124:125]
    v_pk_mul_f32 v[206:207], v[206:207], v[126:127]
    v_exp_f32 v200, v200
    v_exp_f32 v201, v201
    v_exp_f32 v202, v202
    v_exp_f32 v203, v203
    v_exp_f32 v204, v204
    v_exp_f32 v205, v205
    v_exp_f32 v206, v206
    v_exp_f32 v207, v207
    v_pk_mul_f32 v[128:129], v[128:129], v[120:121]
    v_pk_mul_f32 v[130:131], v[130:131], v[122:123]
    v_pk_mul_f32 v[132:133], v[132:133], v[124:125]
    v_pk_mul_f32 v[134:135], v[134:135], v[126:127]
    v_pk_add_f32 v[200:201], v[200:201], 1.0 op_sel_hi:[1,0]
    v_pk_add_f32 v[202:203], v[202:203], 1.0 op_sel_hi:[1,0]
    v_pk_add_f32 v[204:205], v[204:205], 1.0 op_sel_hi:[1,0]
    v_exp_f32 v20, v20
    v_exp_f32 v21, v21
    v_pk_add_f32 v[206:207], v[206:207], 1.0 op_sel_hi:[1,0]
    v_rcp_f32 v200, v200
    v_rcp_f32 v201, v201
    v_rcp_f32 v202, v202
    v_rcp_f32 v203, v203
    v_rcp_f32 v204, v204
    v_rcp_f32 v205, v205
    v_rcp_f32 v206, v206
    v_rcp_f32 v207, v207
    v_pk_mul_f32 v[200:201], v[200:201], v[128:129]
    v_pk_mul_f32 v[202:203], v[202:203], v[130:131]
    v_pk_mul_f32 v[204:205], v[204:205], v[132:133]
    v_pk_mul_f32 v[206:207], v[206:207], v[134:135]
    v_cvt_pk_bf16_f32 v228, v200, v201
    v_cvt_pk_bf16_f32 v229, v202, v203
    v_cvt_pk_bf16_f32 v230, v204, v205
    v_cvt_pk_bf16_f32 v231, v206, v207
    s_add_u32 s4, s4, 120832
    buffer_store_dwordx4 v[228:231], v3, s[52:55], s4 offen sc1
    v_exp_f32 v22, v22
    v_exp_f32 v23, v23
    v_mfma_f32_32x32x16_bf16 v[32:47], v[80:83], v[96:99], 0
    v_cvt_pk_bf16_f32 v16, v16, v17
    v_cvt_pk_bf16_f32 v17, v18, v19
    v_cvt_pk_bf16_f32 v18, v20, v21
    v_cvt_pk_bf16_f32 v19, v22, v23
    v_exp_f32 v24, v24
    v_exp_f32 v25, v25
    s_waitcnt lgkmcnt(0)
    v_mfma_f32_32x32x16_bf16 v[48:63], v[84:87], v[16:19], v[48:63]
    v_pk_mul_f32 v[200:201], v[136:137], v[136:137]
    v_pk_mul_f32 v[202:203], v[138:139], v[138:139]
    v_pk_mul_f32 v[204:205], v[140:141], v[140:141]
    v_pk_mul_f32 v[206:207], v[142:143], v[142:143]
    v_pk_fma_f32 v[200:201], v[200:201], v[210:211], v[208:209]
    v_pk_fma_f32 v[202:203], v[202:203], v[210:211], v[208:209]
    v_pk_fma_f32 v[204:205], v[204:205], v[210:211], v[208:209]
    v_pk_fma_f32 v[206:207], v[206:207], v[210:211], v[208:209]
    v_pk_mul_f32 v[200:201], v[200:201], v[136:137]
    v_pk_mul_f32 v[202:203], v[202:203], v[138:139]
    v_pk_mul_f32 v[204:205], v[204:205], v[140:141]
    v_pk_mul_f32 v[206:207], v[206:207], v[142:143]
    v_exp_f32 v200, v200
    v_exp_f32 v201, v201
    v_exp_f32 v202, v202
    v_exp_f32 v203, v203
    v_exp_f32 v204, v204
    v_exp_f32 v205, v205
    v_exp_f32 v206, v206
    s_barrier
    s_setprio 3
    ds_read_b128 v[80:83], v11 offset:0
    v_exp_f32 v26, v26
    v_exp_f32 v27, v27
    v_exp_f32 v207, v207
    v_pk_mul_f32 v[144:145], v[144:145], v[136:137]
    v_pk_mul_f32 v[146:147], v[146:147], v[138:139]
    v_pk_mul_f32 v[148:149], v[148:149], v[140:141]
    v_pk_mul_f32 v[150:151], v[150:151], v[142:143]
    v_pk_add_f32 v[200:201], v[200:201], 1.0 op_sel_hi:[1,0]
    v_pk_add_f32 v[202:203], v[202:203], 1.0 op_sel_hi:[1,0]
    v_pk_add_f32 v[204:205], v[204:205], 1.0 op_sel_hi:[1,0]
    v_pk_add_f32 v[206:207], v[206:207], 1.0 op_sel_hi:[1,0]
    v_rcp_f32 v200, v200
    v_rcp_f32 v201, v201
    v_rcp_f32 v202, v202
    v_rcp_f32 v203, v203
    v_rcp_f32 v204, v204
    v_rcp_f32 v205, v205
    v_rcp_f32 v206, v206
    v_rcp_f32 v207, v207
    v_pk_mul_f32 v[200:201], v[200:201], v[144:145]
    v_pk_mul_f32 v[202:203], v[202:203], v[146:147]
    v_exp_f32 v28, v28
    v_exp_f32 v29, v29
    v_pk_mul_f32 v[204:205], v[204:205], v[148:149]
    v_pk_mul_f32 v[206:207], v[206:207], v[150:151]
    v_cvt_pk_bf16_f32 v220, v200, v201
    v_cvt_pk_bf16_f32 v221, v202, v203
    v_cvt_pk_bf16_f32 v222, v204, v205
    v_cvt_pk_bf16_f32 v223, v206, v207
    buffer_store_dwordx4 v[220:223], v3, s[52:55], s5 offen sc1
    v_pk_mul_f32 v[200:201], v[152:153], v[152:153]
    v_pk_mul_f32 v[202:203], v[154:155], v[154:155]
    v_pk_mul_f32 v[204:205], v[156:157], v[156:157]
    v_pk_mul_f32 v[206:207], v[158:159], v[158:159]
    v_pk_fma_f32 v[200:201], v[200:201], v[210:211], v[208:209]
    v_pk_fma_f32 v[202:203], v[202:203], v[210:211], v[208:209]
    v_pk_fma_f32 v[204:205], v[204:205], v[210:211], v[208:209]
    v_pk_fma_f32 v[206:207], v[206:207], v[210:211], v[208:209]
    v_pk_mul_f32 v[200:201], v[200:201], v[152:153]
    v_pk_mul_f32 v[202:203], v[202:203], v[154:155]
    v_pk_mul_f32 v[204:205], v[204:205], v[156:157]
    v_pk_mul_f32 v[206:207], v[206:207], v[158:159]
    v_exp_f32 v30, v30
    v_exp_f32 v31, v31
    v_exp_f32 v200, v200
    v_exp_f32 v201, v201
    v_exp_f32 v202, v202
    v_exp_f32 v203, v203
    v_exp_f32 v204, v204
    v_exp_f32 v205, v205
    v_exp_f32 v206, v206
    v_exp_f32 v207, v207
    v_pk_mul_f32 v[160:161], v[160:161], v[152:153]
    v_pk_mul_f32 v[162:163], v[162:163], v[154:155]
    v_pk_mul_f32 v[164:165], v[164:165], v[156:157]
    v_pk_mul_f32 v[166:167], v[166:167], v[158:159]
    v_pk_add_f32 v[200:201], v[200:201], 1.0 op_sel_hi:[1,0]
    v_pk_add_f32 v[202:203], v[202:203], 1.0 op_sel_hi:[1,0]
    v_pk_add_f32 v[204:205], v[204:205], 1.0 op_sel_hi:[1,0]
    v_pk_add_f32 v[206:207], v[206:207], 1.0 op_sel_hi:[1,0]
    v_rcp_f32 v200, v200
    v_rcp_f32 v201, v201
    v_rcp_f32 v202, v202
    v_cvt_pk_bf16_f32 v24, v24, v25
    v_cvt_pk_bf16_f32 v25, v26, v27
    v_cvt_pk_bf16_f32 v26, v28, v29
    v_cvt_pk_bf16_f32 v27, v30, v31
    v_exp_f32 v32, v32
    v_exp_f32 v33, v33
    v_mfma_f32_32x32x16_bf16 v[48:63], v[88:91], v[24:27], v[48:63]
    v_exp_f32 v34, v34
    v_exp_f32 v35, v35
    v_rcp_f32 v203, v203
    v_rcp_f32 v204, v204
    v_rcp_f32 v205, v205
    v_rcp_f32 v206, v206
    v_rcp_f32 v207, v207
    v_pk_mul_f32 v[200:201], v[200:201], v[160:161]
    v_pk_mul_f32 v[202:203], v[202:203], v[162:163]
    v_pk_mul_f32 v[204:205], v[204:205], v[164:165]
    v_pk_mul_f32 v[206:207], v[206:207], v[166:167]
    v_cvt_pk_bf16_f32 v232, v200, v201
    v_cvt_pk_bf16_f32 v233, v202, v203
    v_cvt_pk_bf16_f32 v234, v204, v205
    v_cvt_pk_bf16_f32 v235, v206, v207
    s_add_u32 s5, s5, 120832
    buffer_store_dwordx4 v[232:235], v3, s[52:55], s5 offen sc1
    v_pk_mul_f32 v[200:201], v[168:169], v[168:169]
    v_pk_mul_f32 v[202:203], v[170:171], v[170:171]
    v_pk_mul_f32 v[204:205], v[172:173], v[172:173]
    v_pk_mul_f32 v[206:207], v[174:175], v[174:175]
    v_exp_f32 v36, v36
    v_exp_f32 v37, v37
    v_pk_fma_f32 v[200:201], v[200:201], v[210:211], v[208:209]
    v_pk_fma_f32 v[202:203], v[202:203], v[210:211], v[208:209]
    v_pk_fma_f32 v[204:205], v[204:205], v[210:211], v[208:209]
    v_pk_fma_f32 v[206:207], v[206:207], v[210:211], v[208:209]
    v_pk_mul_f32 v[200:201], v[200:201], v[168:169]
    v_pk_mul_f32 v[202:203], v[202:203], v[170:171]
    v_pk_mul_f32 v[204:205], v[204:205], v[172:173]
    v_pk_mul_f32 v[206:207], v[206:207], v[174:175]
    v_exp_f32 v200, v200
    v_exp_f32 v201, v201
    v_exp_f32 v202, v202
    v_exp_f32 v203, v203
    v_exp_f32 v204, v204
    v_exp_f32 v205, v205
    v_exp_f32 v206, v206
    v_exp_f32 v207, v207
    v_pk_mul_f32 v[176:177], v[176:177], v[168:169]
    v_pk_mul_f32 v[178:179], v[178:179], v[170:171]
    v_pk_mul_f32 v[180:181], v[180:181], v[172:173]
    v_exp_f32 v38, v38
    v_exp_f32 v39, v39
    s_waitcnt lgkmcnt(0)
    v_mfma_f32_32x32x16_bf16 v[16:31], v[80:83], v[92:95], 0
    v_cvt_pk_bf16_f32 v32, v32, v33
    v_cvt_pk_bf16_f32 v33, v34, v35
    v_cvt_pk_bf16_f32 v34, v36, v37
    v_cvt_pk_bf16_f32 v35, v38, v39
    v_pk_mul_f32 v[182:183], v[182:183], v[174:175]
    v_pk_add_f32 v[200:201], v[200:201], 1.0 op_sel_hi:[1,0]
    v_pk_add_f32 v[202:203], v[202:203], 1.0 op_sel_hi:[1,0]
    v_pk_add_f32 v[204:205], v[204:205], 1.0 op_sel_hi:[1,0]
    v_pk_add_f32 v[206:207], v[206:207], 1.0 op_sel_hi:[1,0]
    v_rcp_f32 v200, v200
    v_rcp_f32 v201, v201
    v_rcp_f32 v202, v202
    v_rcp_f32 v203, v203
    v_rcp_f32 v204, v204
    v_rcp_f32 v205, v205
    v_rcp_f32 v206, v206
    v_rcp_f32 v207, v207
    v_pk_mul_f32 v[200:201], v[200:201], v[176:177]
    v_pk_mul_f32 v[202:203], v[202:203], v[178:179]
    v_pk_mul_f32 v[204:205], v[204:205], v[180:181]
    v_pk_mul_f32 v[206:207], v[206:207], v[182:183]
    v_cvt_pk_bf16_f32 v224, v200, v201
    v_cvt_pk_bf16_f32 v225, v202, v203
    v_exp_f32 v40, v40
    v_exp_f32 v41, v41
    v_mfma_f32_32x32x16_bf16 v[64:79], v[84:87], v[32:35], v[64:79]
    s_setprio 3
    s_mov_b64 exec, s[28:29]
    ds_read_b128 v[84:87], v12 offset:0
    s_mov_b64 exec, -1
    v_exp_f32 v42, v42
    v_exp_f32 v43, v43
    v_cvt_pk_bf16_f32 v226, v204, v205
    v_cvt_pk_bf16_f32 v227, v206, v207
    buffer_store_dwordx4 v[224:227], v3, s[52:55], s6 offen sc1
    v_pk_mul_f32 v[200:201], v[184:185], v[184:185]
    v_pk_mul_f32 v[202:203], v[186:187], v[186:187]
    v_pk_mul_f32 v[204:205], v[188:189], v[188:189]
    v_pk_mul_f32 v[206:207], v[190:191], v[190:191]
    v_pk_fma_f32 v[200:201], v[200:201], v[210:211], v[208:209]
    v_pk_fma_f32 v[202:203], v[202:203], v[210:211], v[208:209]
    v_pk_fma_f32 v[204:205], v[204:205], v[210:211], v[208:209]
    v_pk_fma_f32 v[206:207], v[206:207], v[210:211], v[208:209]
    v_pk_mul_f32 v[200:201], v[200:201], v[184:185]
    v_pk_mul_f32 v[202:203], v[202:203], v[186:187]
    v_pk_mul_f32 v[204:205], v[204:205], v[188:189]
    v_pk_mul_f32 v[206:207], v[206:207], v[190:191]
    v_exp_f32 v200, v200
    v_exp_f32 v201, v201
    v_exp_f32 v202, v202
    v_exp_f32 v203, v203
    v_exp_f32 v44, v44
    v_exp_f32 v45, v45
    v_exp_f32 v204, v204
    v_exp_f32 v205, v205
    v_exp_f32 v206, v206
    v_exp_f32 v207, v207
    v_pk_mul_f32 v[192:193], v[192:193], v[184:185]
    v_pk_mul_f32 v[194:195], v[194:195], v[186:187]
    v_pk_mul_f32 v[196:197], v[196:197], v[188:189]
    v_pk_mul_f32 v[198:199], v[198:199], v[190:191]
    v_pk_add_f32 v[200:201], v[200:201], 1.0 op_sel_hi:[1,0]
    v_pk_add_f32 v[202:203], v[202:203], 1.0 op_sel_hi:[1,0]
    v_pk_add_f32 v[204:205], v[204:205], 1.0 op_sel_hi:[1,0]
    v_pk_add_f32 v[206:207], v[206:207], 1.0 op_sel_hi:[1,0]
    v_rcp_f32 v200, v200
    v_rcp_f32 v201, v201
    v_rcp_f32 v202, v202
    v_rcp_f32 v203, v203
    v_rcp_f32 v204, v204
    v_rcp_f32 v205, v205
    v_rcp_f32 v206, v206
    v_exp_f32 v46, v46
    v_exp_f32 v47, v47
    v_rcp_f32 v207, v207
    v_pk_mul_f32 v[200:201], v[200:201], v[192:193]
    v_pk_mul_f32 v[202:203], v[202:203], v[194:195]
    v_pk_mul_f32 v[204:205], v[204:205], v[196:197]
    v_pk_mul_f32 v[206:207], v[206:207], v[198:199]
    v_cvt_pk_bf16_f32 v236, v200, v201
    v_cvt_pk_bf16_f32 v237, v202, v203
    v_cvt_pk_bf16_f32 v238, v204, v205
    v_cvt_pk_bf16_f32 v239, v206, v207
    s_add_u32 s6, s6, 120832
    buffer_store_dwordx4 v[236:239], v3, s[52:55], s6 offen sc1
    v_cvt_pk_bf16_f32 v40, v40, v41
    v_cvt_pk_bf16_f32 v41, v42, v43
    v_cvt_pk_bf16_f32 v42, v44, v45
    v_cvt_pk_bf16_f32 v43, v46, v47
    s_waitcnt lgkmcnt(0)
    s_nop 3
    s_branch LF_join
LF_l0:
    s_barrier
    s_mov_b32 s36, s6
    s_and_b32 s37, s7, 0xffff
    s_mov_b32 s38, 0x80000
    s_mov_b32 s39, 0x20000
    s_and_b32 s79, s72, 3
    s_lshl_b32 s79, s79, 3
    s_and_b32 s89, s74, 7
    s_add_u32 s88, s89, 8
    s_lshl_b32 s90, s73, 7
LF_ldq1:
    s_and_b32 s87, s89, 7
    s_add_u32 s87, s87, s79
    s_mul_i32 s76, s87, 171
    s_lshr_b32 s76, s76, 12
    s_lshl_b32 s77, s87, 2
    s_add_u32 s76, s76, s77
    s_lshl_b32 s76, s76, 8
    s_add_u32 m0, s76, 0x10400
    s_lshl_b32 s78, s87, 13
    s_add_u32 s78, s78, s90
    s_add_u32 s89, s89, 1
    buffer_load_dwordx4 v8, s[36:39], s78 offen lds
    s_cmp_lg_u32 s89, s88
    s_cbranch_scc1 LF_ldq1
    s_add_u32 s79, s79, 24
    s_and_b32 s89, s74, 7
    s_add_u32 s88, s89, 8
    s_lshl_b32 s90, s73, 7
LF_ldq2:
    s_and_b32 s87, s89, 7
    s_add_u32 s87, s87, s79
    s_mul_i32 s76, s87, 171
    s_lshr_b32 s76, s76, 12
    s_lshl_b32 s77, s87, 2
    s_add_u32 s76, s76, s77
    s_lshl_b32 s76, s76, 8
    s_add_u32 m0, s76, 0x10400
    s_lshl_b32 s78, s87, 13
    s_add_u32 s78, s78, s90
    s_add_u32 s89, s89, 1
    buffer_load_dwordx4 v8, s[36:39], s78 offen lds
    s_cmp_lg_u32 s89, s88
    s_cbranch_scc1 LF_ldq2
    s_cmp_eq_u32 s72, 6
    s_cbranch_scc1 LF_l6
    s_add_u32 s79, s79, 24
    s_and_b32 s89, s74, 7
    s_add_u32 s88, s89, 8
    s_lshl_b32 s90, s73, 7
LF_ldq3:
    s_and_b32 s87, s89, 7
    s_add_u32 s87, s87, s79
    s_mul_i32 s76, s87, 171
    s_lshr_b32 s76, s76, 12
    s_lshl_b32 s77, s87, 2
    s_add_u32 s76, s76, s77
    s_lshl_b32 s76, s76, 8
    s_add_u32 m0, s76, 0x10400
    s_lshl_b32 s78, s87, 13
    s_add_u32 s78, s78, s90
    s_add_u32 s89, s89, 1
    buffer_load_dwordx4 v8, s[36:39], s78 offen lds
    s_cmp_lg_u32 s89, s88
    s_cbranch_scc1 LF_ldq3
    s_waitcnt vmcnt(16)
    s_barrier
    s_waitcnt vmcnt(8)
    s_branch LF_l6j
LF_l6:
    s_waitcnt vmcnt(8)
    s_barrier
    s_waitcnt vmcnt(0)
LF_l6j:
    s_barrier
LF_light:
    s_setprio 0
    s_mov_b32 s48, s22
    s_and_b32 s49, s23, 0xffff
    s_mov_b32 s50, 0x400
    s_mov_b32 s51, 0x20000
    s_mov_b32 m0, 0x26f00
    s_nop 0
    buffer_load_dwordx4 v3, s[48:51], 0 offen lds
    s_cmp_eq_u32 s75, 0
    s_cselect_b32 s44, s16, s18
    s_cselect_b32 s45, s17, s19
    s_and_b32 s45, s45, 0xffff
    s_mov_b32 s46, 0x158000
    s_mov_b32 s47, 0x20000
    s_mul_i32 s80, s73, 11
    s_min_u32 s80, s80, 76
    s_cmp_ge_u32 s73, 6
    s_cselect_b32 s81, 10, 11
    s_mul_i32 s80, s73, 11
    s_min_u32 s80, s80, 76
    s_cmp_ge_u32 s73, 6
    s_cselect_b32 s81, 10, 11
    s_lshr_b32 s76, s72, 1
    s_mul_i32 s82, s76, 22016
    s_lshl_b32 s77, s80, 5
    s_add_u32 s82, s82, s77
    s_mul_i32 s83, s76, 3072
    s_mul_i32 s77, s75, 12352
    s_add_u32 s83, s83, s77
    v_add_u32 v6, 0, v2
    v_mul_u32_u24 v240, 2731, v6
    v_lshrrev_b32 v240, 16, v240
    v_mul_u32_u24 v7, 24, v240
    v_sub_u32 v6, v6, v7
    v_and_b32 v7, 2, v240
    v_xor_b32 v6, v6, v7
    v_mul_u32_u24 v240, 2752, v240
    v_lshl_add_u32 v240, v6, 4, v240
    v_lshrrev_b32 v6, 1, v6
    v_mov_b32 v7, 0x40000000
    v_cmp_gt_u32 vcc, s81, v6
    s_nop 1
    v_cndmask_b32 v240, v7, v240, vcc
    v_add_u32 v6, 64, v2
    v_mul_u32_u24 v241, 2731, v6
    v_lshrrev_b32 v241, 16, v241
    v_mul_u32_u24 v7, 24, v241
    v_sub_u32 v6, v6, v7
    v_and_b32 v7, 2, v241
    v_xor_b32 v6, v6, v7
    v_mul_u32_u24 v241, 2752, v241
    v_lshl_add_u32 v241, v6, 4, v241
    v_lshrrev_b32 v6, 1, v6
    v_mov_b32 v7, 0x40000000
    v_cmp_gt_u32 vcc, s81, v6
    s_nop 1
    v_cndmask_b32 v241, v7, v241, vcc
    v_add_u32 v6, 128, v2
    v_mul_u32_u24 v244, 2731, v6
    v_lshrrev_b32 v244, 16, v244
    v_mul_u32_u24 v7, 24, v244
    v_sub_u32 v6, v6, v7
    v_and_b32 v7, 2, v244
    v_xor_b32 v6, v6, v7
    v_mul_u32_u24 v244, 2752, v244
    v_lshl_add_u32 v244, v6, 4, v244
    v_lshrrev_b32 v6, 1, v6
    v_mov_b32 v7, 0x40000000
    v_cmp_gt_u32 vcc, s81, v6
    s_nop 1
    v_cndmask_b32 v244, v7, v244, vcc
    s_lshl_b32 s76, s30, 1
    s_mul_i32 s82, s76, 22016
    s_lshl_b32 s77, s80, 5
    s_add_u32 s82, s82, s77
    s_mul_i32 s83, s76, 3072
    s_mul_i32 s77, s75, 12352
    s_add_u32 s83, s83, s77
    s_add_u32 s82, s82, 0
    v_subrev_u32 v241, 1024, v241
    v_subrev_u32 v244, 2048, v244
    s_barrier
    s_add_u32 m0, s83, 0x10400
    s_add_u32 s79, s82, 0x0
    buffer_load_dwordx4 v240, s[44:47], s79 offen lds
    buffer_load_dwordx4 v241, s[44:47], s79 offen offset:1024 lds
    buffer_load_dwordx4 v244, s[44:47], s79 offen offset:2048 lds
    s_add_u32 m0, s83, 0x11000
    s_add_u32 s79, s82, 0x5600
    buffer_load_dwordx4 v240, s[44:47], s79 offen lds
    buffer_load_dwordx4 v241, s[44:47], s79 offen offset:1024 lds
    buffer_load_dwordx4 v244, s[44:47], s79 offen offset:2048 lds
    s_waitcnt vmcnt(6)
    s_barrier
    s_mov_b32 s56, s24
    s_and_b32 s57, s25, 0xffff
    s_mov_b32 s58, 0x200000
    s_mov_b32 s59, 0x20000
    s_mov_b32 s60, s12
    s_and_b32 s61, s13, 0xffff
    s_mov_b32 s62, 0x80000
    s_mov_b32 s63, 0x20000
    s_mov_b32 s64, s20
    s_and_b32 s65, s21, 0xffff
    s_mov_b32 s66, 0x158000
    s_mov_b32 s67, 0x20000
    s_mov_b32 s48, s22
    s_and_b32 s49, s23, 0xffff
    s_mov_b32 s50, 0x400
    s_mov_b32 s51, 0x20000
    s_mov_b32 s84, 0x7b800000
    s_lshl_b32 s77, s31, 12
    s_add_u32 s77, s77, 0x22700
    s_barrier
    s_add_u32 m0, s83, 0x16500
    s_add_u32 s79, s82, 0x15800
    buffer_load_dwordx4 v240, s[44:47], s79 offen lds
    buffer_load_dwordx4 v241, s[44:47], s79 offen offset:1024 lds
    buffer_load_dwordx4 v244, s[44:47], s79 offen offset:2048 lds
    s_add_u32 m0, s83, 0x17100
    s_add_u32 s79, s82, 0x1ae00
    buffer_load_dwordx4 v240, s[44:47], s79 offen lds
    buffer_load_dwordx4 v241, s[44:47], s79 offen offset:1024 lds
    buffer_load_dwordx4 v244, s[44:47], s79 offen offset:2048 lds
    v_add_u32 v11, s77, v3
    v_lshrrev_b32 v6, 5, v2
    v_lshlrev_b32 v6, 8, v6
    v_and_b32 v7, 15, v2
    v_lshl_add_u32 v6, v7, 4, v6
    v_and_b32 v7, 16, v2
    v_cmp_eq_u32 vcc, 0, v7
    s_add_u32 s77, s77, 2048
    v_mov_b32 v7, s77
    v_add_u32 v7, 0, v7
    v_mov_b32 v12, 0x26700
    v_cndmask_b32 v12, v7, v12, vcc
    v_add_u32 v12, v12, v6
    v_mov_b32 v7, s77
    v_add_u32 v7, 8192, v7
    v_mov_b32 v13, 0x26700
    v_cndmask_b32 v13, v7, v13, vcc
    v_add_u32 v13, v13, v6
    s_lshl_b32 s91, s31, 15
    s_lshl_b32 s77, s30, 16
    s_add_u32 s91, s91, s77
    s_lshl_b32 s77, s75, 10
    s_add_u32 s91, s91, s77
    s_lshl_b32 s92, s72, 10
    s_add_u32 s92, s92, 0x22700
    s_lshl_b32 s76, s30, 1
    s_add_u32 s76, s76, s31
    s_lshl_b32 s77, s73, 2
    s_add_u32 s76, s76, s77
    s_mul_i32 s77, s86, 118
    s_add_u32 s76, s76, s77
    s_lshl_b32 s76, s76, 10
    s_add_u32 s9, s76, 0x415800
    s_lshr_b32 s76, s72, 1
    s_lshl_b32 s76, s76, 3
    s_add_u32 s76, s76, s77
    s_lshl_b32 s76, s76, 10
    s_add_u32 s10, s76, 0x415800
    s_lshl_b32 s8, s74, 10
    s_lshl_b32 s7, s73, 5
    s_add_u32 s7, s7, s72
    s_lshl_b32 s7, s7, 2
    s_add_u32 s7, s7, s8
    s_add_u32 s7, s7, 0x26000
    s_add_u32 s8, s8, 0x26000
    s_lshl_b32 s12, s72, 14
    s_lshl_b32 s77, s73, 7
    s_add_u32 s12, s12, s77
    s_lshl_b32 s15, s72, 11
    v_and_b32 v6, 31, v2
    s_lshl_b32 s76, s75, 5
    v_add_u32 v6, s76, v6
    v_mul_u32_u24 v14, 1040, v6
    v_lshrrev_b32 v6, 5, v2
    v_lshl_add_u32 v14, v6, 4, v14
    s_and_b32 s76, s72, 3
    s_lshl_b32 s77, s76, 11
    s_add_u32 s77, s77, 0x24700
    v_add_u32 v15, s77, v3
    v_lshrrev_b32 v6, 5, v2
    v_lshlrev_b32 v120, 4, v6
    s_lshl_b32 s76, s30, 9
    v_add_u32 v14, s76, v14
    s_add_u32 s76, s76, 0x26f00
    v_add_u32 v120, s76, v120
    s_lshl_b32 s76, s72, 8
    s_add_u32 s76, s76, 0x26300
    v_lshlrev_b32 v6, 2, v2
    v_add_u32 v6, s76, v6
    v_mov_b32 v7, 0x3f803f80
    v_lshrrev_b32 v1, 2, v2
    v_and_b32 v1, 11, v1
    v_cmp_eq_u32 vcc, 0, v1
    s_nop 1
    v_cndmask_b32 v7, 0, v7, vcc
    ds_write_b32 v6, v7
    ds_write_b32 v6, v7 offset:1024
    s_mov_b32 s89, 0x24000
    s_waitcnt vmcnt(6)
    s_waitcnt lgkmcnt(0)
    s_barrier
    ds_read_b128 v[92:95], v15 offset:1024
    ds_read_b128 v[96:99], v15
    s_add_u32 m0, s83, 0x1c600
    s_add_u32 s79, s82, 0x2b000
    buffer_load_dwordx4 v240, s[44:47], s79 offen lds
    buffer_load_dwordx4 v241, s[44:47], s79 offen offset:1024 lds
    buffer_load_dwordx4 v244, s[44:47], s79 offen offset:2048 lds
    s_add_u32 m0, s83, 0x1d200
    s_add_u32 s79, s82, 0x30600
    buffer_load_dwordx4 v240, s[44:47], s79 offen lds
    buffer_load_dwordx4 v241, s[44:47], s79 offen offset:1024 lds
    buffer_load_dwordx4 v244, s[44:47], s79 offen offset:2048 lds
    buffer_load_dword v10, v9, s[68:71], 0 offen sc1
    v_mov_b32 v104, 0
    v_mov_b32 v105, 0
    v_mov_b32 v106, 0
    v_mov_b32 v107, 0
    ds_read_b128 v[136:139], v14 offset:0
    ds_read_b128 v[168:171], v120 offset:0
    ds_read_b128 v[140:143], v14 offset:32
    ds_read_b128 v[172:175], v120 offset:32
    ds_read_b128 v[144:147], v14 offset:64
    ds_read_b128 v[176:179], v120 offset:64
    s_waitcnt lgkmcnt(4)
    v_dot2c_f32_bf16 v104, v136, v168
    v_dot2c_f32_bf16 v105, v137, v169
    v_dot2c_f32_bf16 v106, v138, v170
    v_dot2c_f32_bf16 v107, v139, v171
    ds_read_b128 v[148:151], v14 offset:96
    ds_read_b128 v[180:183], v120 offset:96
    s_waitcnt lgkmcnt(3)
    v_dot2c_f32_bf16 v104, v140, v172
    v_dot2c_f32_bf16 v105, v141, v173
    v_dot2c_f32_bf16 v106, v142, v174
    v_dot2c_f32_bf16 v107, v143, v175
    ds_read_b128 v[136:139], v14 offset:128
    ds_read_b128 v[168:171], v120 offset:128
    s_waitcnt lgkmcnt(3)
    v_dot2c_f32_bf16 v104, v144, v176
    v_dot2c_f32_bf16 v105, v145, v177
    v_dot2c_f32_bf16 v106, v146, v178
    v_dot2c_f32_bf16 v107, v147, v179
    ds_read_b128 v[140:143], v14 offset:160
    ds_read_b128 v[172:175], v120 offset:160
    s_waitcnt lgkmcnt(3)
    v_dot2c_f32_bf16 v104, v148, v180
    v_dot2c_f32_bf16 v105, v149, v181
    v_dot2c_f32_bf16 v106, v150, v182
    v_dot2c_f32_bf16 v107, v151, v183
    ds_read_b128 v[144:147], v14 offset:192
    ds_read_b128 v[176:179], v120 offset:192
    s_waitcnt lgkmcnt(3)
    v_dot2c_f32_bf16 v104, v136, v168
    v_dot2c_f32_bf16 v105, v137, v169
    v_dot2c_f32_bf16 v106, v138, v170
    v_dot2c_f32_bf16 v107, v139, v171
    ds_read_b128 v[148:151], v14 offset:224
    ds_read_b128 v[180:183], v120 offset:224
    s_waitcnt lgkmcnt(3)
    v_dot2c_f32_bf16 v104, v140, v172
    v_dot2c_f32_bf16 v105, v141, v173
    v_dot2c_f32_bf16 v106, v142, v174
    v_dot2c_f32_bf16 v107, v143, v175
    ds_read_b128 v[136:139], v14 offset:256
    ds_read_b128 v[168:171], v120 offset:256
    s_waitcnt lgkmcnt(3)
    v_dot2c_f32_bf16 v104, v144, v176
    v_dot2c_f32_bf16 v105, v145, v177
    v_dot2c_f32_bf16 v106, v146, v178
    v_dot2c_f32_bf16 v107, v147, v179
    ds_read_b128 v[140:143], v14 offset:288
    ds_read_b128 v[172:175], v120 offset:288
    s_waitcnt lgkmcnt(3)
    v_dot2c_f32_bf16 v104, v148, v180
    v_dot2c_f32_bf16 v105, v149, v181
    v_dot2c_f32_bf16 v106, v150, v182
    v_dot2c_f32_bf16 v107, v151, v183
    ds_read_b128 v[144:147], v14 offset:320
    ds_read_b128 v[176:179], v120 offset:320
    s_waitcnt lgkmcnt(3)
    v_dot2c_f32_bf16 v104, v136, v168
    v_dot2c_f32_bf16 v105, v137, v169
    v_dot2c_f32_bf16 v106, v138, v170
    v_dot2c_f32_bf16 v107, v139, v171
    ds_read_b128 v[148:151], v14 offset:352
    ds_read_b128 v[180:183], v120 offset:352
    s_waitcnt lgkmcnt(3)
    v_dot2c_f32_bf16 v104, v140, v172
    v_dot2c_f32_bf16 v105, v141, v173
    v_dot2c_f32_bf16 v106, v142, v174
    v_dot2c_f32_bf16 v107, v143, v175
    ds_read_b128 v[136:139], v14 offset:384
    ds_read_b128 v[168:171], v120 offset:384
    s_waitcnt lgkmcnt(3)
    v_dot2c_f32_bf16 v104, v144, v176
    v_dot2c_f32_bf16 v105, v145, v177
    v_dot2c_f32_bf16 v106, v146, v178
    v_dot2c_f32_bf16 v107, v147, v179
    ds_read_b128 v[140:143], v14 offset:416
    ds_read_b128 v[172:175], v120 offset:416
    s_waitcnt lgkmcnt(3)
    v_dot2c_f32_bf16 v104, v148, v180
    v_dot2c_f32_bf16 v105, v149, v181
    v_dot2c_f32_bf16 v106, v150, v182
    v_dot2c_f32_bf16 v107, v151, v183
    ds_read_b128 v[144:147], v14 offset:448
    ds_read_b128 v[176:179], v120 offset:448
    s_waitcnt lgkmcnt(3)
    v_dot2c_f32_bf16 v104, v136, v168
    v_dot2c_f32_bf16 v105, v137, v169
    v_dot2c_f32_bf16 v106, v138, v170
    v_dot2c_f32_bf16 v107, v139, v171
    ds_read_b128 v[148:151], v14 offset:480
    ds_read_b128 v[180:183], v120 offset:480
    s_waitcnt lgkmcnt(3)
    v_dot2c_f32_bf16 v104, v140, v172
    v_dot2c_f32_bf16 v105, v141, v173
    v_dot2c_f32_bf16 v106, v142, v174
    v_dot2c_f32_bf16 v107, v143, v175
    s_waitcnt lgkmcnt(2)
    v_dot2c_f32_bf16 v104, v144, v176
    v_dot2c_f32_bf16 v105, v145, v177
    v_dot2c_f32_bf16 v106, v146, v178
    v_dot2c_f32_bf16 v107, v147, v179
    s_waitcnt lgkmcnt(0)
    v_dot2c_f32_bf16 v104, v148, v180
    v_dot2c_f32_bf16 v105, v149, v181
    v_dot2c_f32_bf16 v106, v150, v182
    v_dot2c_f32_bf16 v107, v151, v183
    s_nop 2
    v_add_f32 v104, v104, v105
    v_add_f32 v106, v106, v107
    v_add_f32 v104, v104, v106
    s_and_b32 s76, s72, 3
    s_lshl_b32 s76, s76, 8
    s_add_u32 s76, s76, 0x27300
    v_lshlrev_b32 v6, 2, v2
    v_add_u32 v6, s76, v6
    ds_write_b32 v6, v104
    s_waitcnt vmcnt(7)
    s_waitcnt lgkmcnt(0)
    s_barrier
    s_add_u32 m0, s83, 0x10400
    s_add_u32 s79, s82, 0x40800
    buffer_load_dwordx4 v240, s[44:47], s79 offen lds
    buffer_load_dwordx4 v241, s[44:47], s79 offen offset:1024 lds
    buffer_load_dwordx4 v244, s[44:47], s79 offen offset:2048 lds
    s_add_u32 m0, s83, 0x11000
    s_add_u32 s79, s82, 0x45e00
    buffer_load_dwordx4 v240, s[44:47], s79 offen lds
    buffer_load_dwordx4 v241, s[44:47], s79 offen offset:1024 lds
    buffer_load_dwordx4 v244, s[44:47], s79 offen offset:2048 lds
    s_waitcnt vmcnt(7)
    s_barrier
    s_add_u32 m0, s92, 0x2000
    s_add_u32 s78, s91, 2048
    buffer_load_dwordx4 v3, s[52:55], s78 offen sc1 lds
    s_add_u32 m0, s92, 0x1000
    s_sub_u32 s78, s78, 32768
    buffer_load_dwordx4 v3, s[52:55], s78 offen sc1 lds
    s_mov_b32 s28, 0xffff0000
    s_mov_b32 s29, 0xffff0000
    ds_read_b128 v[80:83], v11 offset:0
    ds_read_b128 v[84:87], v12 offset:0
    s_waitcnt lgkmcnt(1)
    v_mfma_f32_32x32x16_bf16 v[16:31], v[80:83], v[92:95], 0
    s_nop 11
    v_exp_f32 v16, v16
    v_exp_f32 v17, v17
    ds_read_b128 v[88:91], v12 offset:512
    s_setprio 0
    s_add_u32 m0, s83, 0x16500
    s_add_u32 s79, s82, 0x56000
    buffer_load_dwordx4 v240, s[44:47], s79 offen lds
    v_exp_f32 v18, v18
    v_exp_f32 v19, v19
    buffer_load_dwordx4 v241, s[44:47], s79 offen offset:1024 lds
    v_exp_f32 v20, v20
    v_exp_f32 v21, v21
    buffer_load_dwordx4 v244, s[44:47], s79 offen offset:2048 lds
    v_exp_f32 v22, v22
    v_exp_f32 v23, v23
    v_mfma_f32_32x32x16_bf16 v[32:47], v[80:83], v[96:99], 0
    v_cvt_pk_bf16_f32 v16, v16, v17
    v_cvt_pk_bf16_f32 v17, v18, v19
    v_cvt_pk_bf16_f32 v18, v20, v21
    v_cvt_pk_bf16_f32 v19, v22, v23
    v_exp_f32 v24, v24
    v_exp_f32 v25, v25
    s_waitcnt lgkmcnt(0)
    v_mfma_f32_32x32x16_bf16 v[48:63], v[84:87], v[16:19], 0
    s_setprio 3
    ds_read_b128 v[80:83], v11 offset:1024
    s_add_u32 m0, s83, 0x17100
    s_add_u32 s79, s82, 0x5b600
    buffer_load_dwordx4 v240, s[44:47], s79 offen lds
    v_exp_f32 v26, v26
    v_exp_f32 v27, v27
    buffer_load_dwordx4 v241, s[44:47], s79 offen offset:1024 lds
    v_exp_f32 v28, v28
    v_exp_f32 v29, v29
    buffer_load_dwordx4 v244, s[44:47], s79 offen offset:2048 lds
    v_exp_f32 v30, v30
    v_exp_f32 v31, v31
    v_cvt_pk_bf16_f32 v24, v24, v25
    v_cvt_pk_bf16_f32 v25, v26, v27
    v_cvt_pk_bf16_f32 v26, v28, v29
    v_cvt_pk_bf16_f32 v27, v30, v31
    v_exp_f32 v32, v32
    v_exp_f32 v33, v33
    v_mfma_f32_32x32x16_bf16 v[48:63], v[88:91], v[24:27], v[48:63]
    s_setprio 2
    v_exp_f32 v34, v34
    v_exp_f32 v35, v35
    v_exp_f32 v36, v36
    v_exp_f32 v37, v37
    v_exp_f32 v38, v38
    v_exp_f32 v39, v39
    s_waitcnt lgkmcnt(0)
    v_mfma_f32_32x32x16_bf16 v[16:31], v[80:83], v[92:95], 0
    v_cvt_pk_bf16_f32 v32, v32, v33
    v_cvt_pk_bf16_f32 v33, v34, v35
    v_cvt_pk_bf16_f32 v34, v36, v37
    v_cvt_pk_bf16_f32 v35, v38, v39
    v_exp_f32 v40, v40
    v_exp_f32 v41, v41
    v_mfma_f32_32x32x16_bf16 v[64:79], v[84:87], v[32:35], 0
    s_setprio 1
    s_mov_b64 exec, s[28:29]
    ds_read_b128 v[84:87], v12 offset:1024
    s_mov_b64 exec, -1
    v_exp_f32 v42, v42
    v_exp_f32 v43, v43
    v_exp_f32 v44, v44
    v_exp_f32 v45, v45
    v_exp_f32 v46, v46
    v_exp_f32 v47, v47
    v_cvt_pk_bf16_f32 v40, v40, v41
    v_cvt_pk_bf16_f32 v41, v42, v43
    v_cvt_pk_bf16_f32 v42, v44, v45
    v_cvt_pk_bf16_f32 v43, v46, v47
    v_exp_f32 v16, v16
    v_exp_f32 v17, v17
    v_mfma_f32_32x32x16_bf16 v[64:79], v[88:91], v[40:43], v[64:79]
    s_mov_b64 exec, s[28:29]
    ds_read_b128 v[88:91], v12 offset:1536
    s_mov_b64 exec, -1
    s_setprio 0
    v_exp_f32 v18, v18
    v_exp_f32 v19, v19
    v_exp_f32 v20, v20
    v_exp_f32 v21, v21
    v_exp_f32 v22, v22
    v_exp_f32 v23, v23
    v_mfma_f32_32x32x16_bf16 v[32:47], v[80:83], v[96:99], 0
    v_cvt_pk_bf16_f32 v16, v16, v17
    v_cvt_pk_bf16_f32 v17, v18, v19
    v_cvt_pk_bf16_f32 v18, v20, v21
    v_cvt_pk_bf16_f32 v19, v22, v23
    v_exp_f32 v24, v24
    v_exp_f32 v25, v25
    s_waitcnt lgkmcnt(0)
    v_mfma_f32_32x32x16_bf16 v[48:63], v[84:87], v[16:19], v[48:63]
    s_waitcnt vmcnt(6)
    s_barrier
    s_setprio 3
    ds_read_b128 v[80:83], v11 offset:8192
    s_mov_b32 m0, s92
    s_add_u32 s78, s91, 4096
    buffer_load_dwordx4 v3, s[52:55], s78 offen sc1 lds
    s_add_u32 m0, s92, 0xfffff000
    s_sub_u32 s78, s78, 32768
    buffer_load_dwordx4 v3, s[52:55], s78 offen sc1 lds
    s_add_u32 m0, s83, 0x1c600
    s_add_u32 s79, s82, 0x6b800
    buffer_load_dwordx4 v240, s[44:47], s79 offen lds
    v_exp_f32 v26, v26
    v_exp_f32 v27, v27
    buffer_load_dwordx4 v241, s[44:47], s79 offen offset:1024 lds
    v_exp_f32 v28, v28
    v_exp_f32 v29, v29
    buffer_load_dwordx4 v244, s[44:47], s79 offen offset:2048 lds
    v_exp_f32 v30, v30
    v_exp_f32 v31, v31
    s_add_u32 m0, s83, 0x1d200
    s_add_u32 s79, s82, 0x70e00
    buffer_load_dwordx4 v240, s[44:47], s79 offen lds
    v_cvt_pk_bf16_f32 v24, v24, v25
    v_cvt_pk_bf16_f32 v25, v26, v27
    v_cvt_pk_bf16_f32 v26, v28, v29
    v_cvt_pk_bf16_f32 v27, v30, v31
    v_exp_f32 v32, v32
    v_exp_f32 v33, v33
    v_mfma_f32_32x32x16_bf16 v[48:63], v[88:91], v[24:27], v[48:63]
    s_setprio 2
    buffer_load_dwordx4 v241, s[44:47], s79 offen offset:1024 lds
    v_exp_f32 v34, v34
    v_exp_f32 v35, v35
    buffer_load_dwordx4 v244, s[44:47], s79 offen offset:2048 lds
    v_exp_f32 v36, v36
    v_exp_f32 v37, v37
    v_exp_f32 v38, v38
    v_exp_f32 v39, v39
    s_waitcnt lgkmcnt(0)
    v_mfma_f32_32x32x16_bf16 v[16:31], v[80:83], v[92:95], 0
    v_cvt_pk_bf16_f32 v32, v32, v33
    v_cvt_pk_bf16_f32 v33, v34, v35
    v_cvt_pk_bf16_f32 v34, v36, v37
    v_cvt_pk_bf16_f32 v35, v38, v39
    v_exp_f32 v40, v40
    v_exp_f32 v41, v41
    v_mfma_f32_32x32x16_bf16 v[64:79], v[84:87], v[32:35], v[64:79]
    s_setprio 1
    s_mov_b64 exec, s[28:29]
    ds_read_b128 v[84:87], v13 offset:0
    s_mov_b64 exec, -1
    v_exp_f32 v42, v42
    v_exp_f32 v43, v43
    v_exp_f32 v44, v44
    v_exp_f32 v45, v45
    v_exp_f32 v46, v46
    v_exp_f32 v47, v47
    v_cvt_pk_bf16_f32 v40, v40, v41
    v_cvt_pk_bf16_f32 v41, v42, v43
    v_cvt_pk_bf16_f32 v42, v44, v45
    v_cvt_pk_bf16_f32 v43, v46, v47
    v_exp_f32 v16, v16
    v_exp_f32 v17, v17
    v_mfma_f32_32x32x16_bf16 v[64:79], v[88:91], v[40:43], v[64:79]
    s_mov_b64 exec, s[28:29]
    ds_read_b128 v[88:91], v13 offset:512
    s_mov_b64 exec, -1
    s_setprio 0
    v_exp_f32 v18, v18
    v_exp_f32 v19, v19
    v_exp_f32 v20, v20
    v_exp_f32 v21, v21
    v_exp_f32 v22, v22
    v_exp_f32 v23, v23
    v_mfma_f32_32x32x16_bf16 v[32:47], v[80:83], v[96:99], 0
    v_cvt_pk_bf16_f32 v16, v16, v17
    v_cvt_pk_bf16_f32 v17, v18, v19
    v_cvt_pk_bf16_f32 v18, v20, v21
    v_cvt_pk_bf16_f32 v19, v22, v23
    v_exp_f32 v24, v24
    v_exp_f32 v25, v25
    s_waitcnt lgkmcnt(0)
    v_mfma_f32_32x32x16_bf16 v[48:63], v[84:87], v[16:19], v[48:63]
    s_waitcnt vmcnt(8)
    s_barrier
    s_setprio 3
    ds_read_b128 v[80:83], v11 offset:9216
    s_add_u32 m0, s83, 0x10400
    s_add_u32 s79, s82, 0x81000
    buffer_load_dwordx4 v240, s[44:47], s79 offen lds
    v_exp_f32 v26, v26
    v_exp_f32 v27, v27
    buffer_load_dwordx4 v241, s[44:47], s79 offen offset:1024 lds
    v_exp_f32 v28, v28
    v_exp_f32 v29, v29
    buffer_load_dwordx4 v244, s[44:47], s79 offen offset:2048 lds
    v_exp_f32 v30, v30
    v_exp_f32 v31, v31
    s_add_u32 m0, s83, 0x11000
    s_add_u32 s79, s82, 0x86600
    buffer_load_dwordx4 v240, s[44:47], s79 offen lds
    v_cvt_pk_bf16_f32 v24, v24, v25
    v_cvt_pk_bf16_f32 v25, v26, v27
    v_cvt_pk_bf16_f32 v26, v28, v29
    v_cvt_pk_bf16_f32 v27, v30, v31
    v_exp_f32 v32, v32
    v_exp_f32 v33, v33
    v_mfma_f32_32x32x16_bf16 v[48:63], v[88:91], v[24:27], v[48:63]
    s_setprio 2
    buffer_load_dwordx4 v241, s[44:47], s79 offen offset:1024 lds
    v_exp_f32 v34, v34
    v_exp_f32 v35, v35
    buffer_load_dwordx4 v244, s[44:47], s79 offen offset:2048 lds
    v_exp_f32 v36, v36
    v_exp_f32 v37, v37
    v_exp_f32 v38, v38
    v_exp_f32 v39, v39
    s_waitcnt lgkmcnt(0)
    v_mfma_f32_32x32x16_bf16 v[16:31], v[80:83], v[92:95], 0
    v_cvt_pk_bf16_f32 v32, v32, v33
    v_cvt_pk_bf16_f32 v33, v34, v35
    v_cvt_pk_bf16_f32 v34, v36, v37
    v_cvt_pk_bf16_f32 v35, v38, v39
    v_exp_f32 v40, v40
    v_exp_f32 v41, v41
    v_mfma_f32_32x32x16_bf16 v[64:79], v[84:87], v[32:35], v[64:79]
    s_setprio 1
    s_mov_b64 exec, s[28:29]
    ds_read_b128 v[84:87], v13 offset:1024
    s_mov_b64 exec, -1
    v_exp_f32 v42, v42
    v_exp_f32 v43, v43
    v_exp_f32 v44, v44
    v_exp_f32 v45, v45
    v_exp_f32 v46, v46
    v_exp_f32 v47, v47
    v_cvt_pk_bf16_f32 v40, v40, v41
    v_cvt_pk_bf16_f32 v41, v42, v43
    v_cvt_pk_bf16_f32 v42, v44, v45
    v_cvt_pk_bf16_f32 v43, v46, v47
    v_exp_f32 v16, v16
    v_exp_f32 v17, v17
    v_mfma_f32_32x32x16_bf16 v[64:79], v[88:91], v[40:43], v[64:79]
    s_mov_b64 exec, s[28:29]
    ds_read_b128 v[88:91], v13 offset:1536
    s_mov_b64 exec, -1
    s_setprio 0
    v_exp_f32 v18, v18
    v_exp_f32 v19, v19
    v_exp_f32 v20, v20
    v_exp_f32 v21, v21
    v_exp_f32 v22, v22
    v_exp_f32 v23, v23
    v_mfma_f32_32x32x16_bf16 v[32:47], v[80:83], v[96:99], 0
    v_cvt_pk_bf16_f32 v16, v16, v17
    v_cvt_pk_bf16_f32 v17, v18, v19
    v_cvt_pk_bf16_f32 v18, v20, v21
    v_cvt_pk_bf16_f32 v19, v22, v23
    v_exp_f32 v24, v24
    v_exp_f32 v25, v25
    s_waitcnt lgkmcnt(0)
    v_mfma_f32_32x32x16_bf16 v[48:63], v[84:87], v[16:19], v[48:63]
    s_waitcnt vmcnt(12)
    s_waitcnt vmcnt(6)
    s_barrier
    s_setprio 3
    ds_read_b128 v[80:83], v11 offset:0
    s_add_u32 m0, s92, 0x2000
    s_add_u32 s78, s91, 6144
    buffer_load_dwordx4 v3, s[52:55], s78 offen sc1 lds
    s_add_u32 m0, s92, 0x1000
    s_sub_u32 s78, s78, 32768
    buffer_load_dwordx4 v3, s[52:55], s78 offen sc1 lds
    s_add_u32 m0, s83, 0x16500
    s_add_u32 s79, s82, 0x96800
    buffer_load_dwordx4 v240, s[44:47], s79 offen lds
    v_exp_f32 v26, v26
    v_exp_f32 v27, v27
    buffer_load_dwordx4 v241, s[44:47], s79 offen offset:1024 lds
    v_exp_f32 v28, v28
    v_exp_f32 v29, v29
    buffer_load_dwordx4 v244, s[44:47], s79 offen offset:2048 lds
    v_exp_f32 v30, v30
    v_exp_f32 v31, v31
    s_add_u32 m0, s83, 0x17100
    s_add_u32 s79, s82, 0x9be00
    buffer_load_dwordx4 v240, s[44:47], s79 offen lds
    v_cvt_pk_bf16_f32 v24, v24, v25
    v_cvt_pk_bf16_f32 v25, v26, v27
    v_cvt_pk_bf16_f32 v26, v28, v29
    v_cvt_pk_bf16_f32 v27, v30, v31
    v_exp_f32 v32, v32
    v_exp_f32 v33, v33
    v_mfma_f32_32x32x16_bf16 v[48:63], v[88:91], v[24:27], v[48:63]
    s_setprio 2
    buffer_load_dwordx4 v241, s[44:47], s79 offen offset:1024 lds
    v_exp_f32 v34, v34
    v_exp_f32 v35, v35
    buffer_load_dwordx4 v244, s[44:47], s79 offen offset:2048 lds
    v_exp_f32 v36, v36
    v_exp_f32 v37, v37
    v_exp_f32 v38, v38
    v_exp_f32 v39, v39
    s_waitcnt lgkmcnt(0)
    v_mfma_f32_32x32x16_bf16 v[16:31], v[80:83], v[92:95], 0
    v_cvt_pk_bf16_f32 v32, v32, v33
    v_cvt_pk_bf16_f32 v33, v34, v35
    v_cvt_pk_bf16_f32 v34, v36, v37
    v_cvt_pk_bf16_f32 v35, v38, v39
    v_exp_f32 v40, v40
    v_exp_f32 v41, v41
    v_mfma_f32_32x32x16_bf16 v[64:79], v[84:87], v[32:35], v[64:79]
    s_setprio 1
    s_mov_b64 exec, s[28:29]
    ds_read_b128 v[84:87], v12 offset:0
    s_mov_b64 exec, -1
    v_exp_f32 v42, v42
    v_exp_f32 v43, v43
    v_exp_f32 v44, v44
    v_exp_f32 v45, v45
    v_exp_f32 v46, v46
    v_exp_f32 v47, v47
    v_cvt_pk_bf16_f32 v40, v40, v41
    v_cvt_pk_bf16_f32 v41, v42, v43
    v_cvt_pk_bf16_f32 v42, v44, v45
    v_cvt_pk_bf16_f32 v43, v46, v47
    v_exp_f32 v16, v16
    v_exp_f32 v17, v17
    v_mfma_f32_32x32x16_bf16 v[64:79], v[88:91], v[40:43], v[64:79]
    s_mov_b64 exec, s[28:29]
    ds_read_b128 v[88:91], v12 offset:512
    s_mov_b64 exec, -1
    s_setprio 0
    v_exp_f32 v18, v18
    v_exp_f32 v19, v19
    v_exp_f32 v20, v20
    v_exp_f32 v21, v21
    v_exp_f32 v22, v22
    v_exp_f32 v23, v23
    v_mfma_f32_32x32x16_bf16 v[32:47], v[80:83], v[96:99], 0
    v_cvt_pk_bf16_f32 v16, v16, v17
    v_cvt_pk_bf16_f32 v17, v18, v19
    v_cvt_pk_bf16_f32 v18, v20, v21
    v_cvt_pk_bf16_f32 v19, v22, v23
    v_exp_f32 v24, v24
    v_exp_f32 v25, v25
    s_waitcnt lgkmcnt(0)
    v_mfma_f32_32x32x16_bf16 v[48:63], v[84:87], v[16:19], v[48:63]
    s_waitcnt vmcnt(8)
    s_barrier
    s_setprio 3
    ds_read_b128 v[80:83], v11 offset:1024
    s_add_u32 m0, s83, 0x1c600
    s_add_u32 s79, s82, 0xac000
    buffer_load_dwordx4 v240, s[44:47], s79 offen lds
    v_exp_f32 v26, v26
    v_exp_f32 v27, v27
    buffer_load_dwordx4 v241, s[44:47], s79 offen offset:1024 lds
    v_exp_f32 v28, v28
    v_exp_f32 v29, v29
    buffer_load_dwordx4 v244, s[44:47], s79 offen offset:2048 lds
    v_exp_f32 v30, v30
    v_exp_f32 v31, v31
    s_add_u32 m0, s83, 0x1d200
    s_add_u32 s79, s82, 0xb1600
    buffer_load_dwordx4 v240, s[44:47], s79 offen lds
    v_cvt_pk_bf16_f32 v24, v24, v25
    v_cvt_pk_bf16_f32 v25, v26, v27
    v_cvt_pk_bf16_f32 v26, v28, v29
    v_cvt_pk_bf16_f32 v27, v30, v31
    v_exp_f32 v32, v32
    v_exp_f32 v33, v33
    v_mfma_f32_32x32x16_bf16 v[48:63], v[88:91], v[24:27], v[48:63]
    s_setprio 2
    buffer_load_dwordx4 v241, s[44:47], s79 offen offset:1024 lds
    v_exp_f32 v34, v34
    v_exp_f32 v35, v35
    buffer_load_dwordx4 v244, s[44:47], s79 offen offset:2048 lds
    v_exp_f32 v36, v36
    v_exp_f32 v37, v37
    v_exp_f32 v38, v38
    v_exp_f32 v39, v39
    s_waitcnt lgkmcnt(0)
    v_mfma_f32_32x32x16_bf16 v[16:31], v[80:83], v[92:95], 0
    v_cvt_pk_bf16_f32 v32, v32, v33
    v_cvt_pk_bf16_f32 v33, v34, v35
    v_cvt_pk_bf16_f32 v34, v36, v37
    v_cvt_pk_bf16_f32 v35, v38, v39
    v_exp_f32 v40, v40
    v_exp_f32 v41, v41
    v_mfma_f32_32x32x16_bf16 v[64:79], v[84:87], v[32:35], v[64:79]
    s_setprio 1
    s_mov_b64 exec, s[28:29]
    ds_read_b128 v[84:87], v12 offset:1024
    s_mov_b64 exec, -1
    v_exp_f32 v42, v42
    v_exp_f32 v43, v43
    v_exp_f32 v44, v44
    v_exp_f32 v45, v45
    v_exp_f32 v46, v46
    v_exp_f32 v47, v47
    v_cvt_pk_bf16_f32 v40, v40, v41
    v_cvt_pk_bf16_f32 v41, v42, v43
    v_cvt_pk_bf16_f32 v42, v44, v45
    v_cvt_pk_bf16_f32 v43, v46, v47
    v_exp_f32 v16, v16
    v_exp_f32 v17, v17
    v_mfma_f32_32x32x16_bf16 v[64:79], v[88:91], v[40:43], v[64:79]
    s_mov_b64 exec, s[28:29]
    ds_read_b128 v[88:91], v12 offset:1536
    s_mov_b64 exec, -1
    s_setprio 0
    v_exp_f32 v18, v18
    v_exp_f32 v19, v19
    v_exp_f32 v20, v20
    v_exp_f32 v21, v21
    v_exp_f32 v22, v22
    v_exp_f32 v23, v23
    v_mfma_f32_32x32x16_bf16 v[32:47], v[80:83], v[96:99], 0
    v_cvt_pk_bf16_f32 v16, v16, v17
    v_cvt_pk_bf16_f32 v17, v18, v19
    v_cvt_pk_bf16_f32 v18, v20, v21
    v_cvt_pk_bf16_f32 v19, v22, v23
    v_exp_f32 v24, v24
    v_exp_f32 v25, v25
    s_waitcnt lgkmcnt(0)
    v_mfma_f32_32x32x16_bf16 v[48:63], v[84:87], v[16:19], v[48:63]
    s_waitcnt vmcnt(12)
    s_waitcnt vmcnt(6)
    s_barrier
    s_setprio 3
    ds_read_b128 v[80:83], v11 offset:8192
    s_mov_b32 m0, s92
    s_add_u32 s78, s91, 8192
    buffer_load_dwordx4 v3, s[52:55], s78 offen sc1 lds
    s_add_u32 m0, s92, 0xfffff000
    s_sub_u32 s78, s78, 32768
    buffer_load_dwordx4 v3, s[52:55], s78 offen sc1 lds
    s_add_u32 m0, s83, 0x10400
    s_add_u32 s79, s82, 0xc1800
    buffer_load_dwordx4 v240, s[44:47], s79 offen lds
    v_exp_f32 v26, v26
    v_exp_f32 v27, v27
    buffer_load_dwordx4 v241, s[44:47], s79 offen offset:1024 lds
    v_exp_f32 v28, v28
    v_exp_f32 v29, v29
    buffer_load_dwordx4 v244, s[44:47], s79 offen offset:2048 lds
    v_exp_f32 v30, v30
    v_exp_f32 v31, v31
    s_add_u32 m0, s83, 0x11000
    s_add_u32 s79, s82, 0xc6e00
    buffer_load_dwordx4 v240, s[44:47], s79 offen lds
    v_cvt_pk_bf16_f32 v24, v24, v25
    v_cvt_pk_bf16_f32 v25, v26, v27
    v_cvt_pk_bf16_f32 v26, v28, v29
    v_cvt_pk_bf16_f32 v27, v30, v31
    v_exp_f32 v32, v32
    v_exp_f32 v33, v33
    v_mfma_f32_32x32x16_bf16 v[48:63], v[88:91], v[24:27], v[48:63]
    s_setprio 2
    buffer_load_dwordx4 v241, s[44:47], s79 offen offset:1024 lds
    v_exp_f32 v34, v34
    v_exp_f32 v35, v35
    buffer_load_dwordx4 v244, s[44:47], s79 offen offset:2048 lds
    v_exp_f32 v36, v36
    v_exp_f32 v37, v37
    v_exp_f32 v38, v38
    v_exp_f32 v39, v39
    s_waitcnt lgkmcnt(0)
    v_mfma_f32_32x32x16_bf16 v[16:31], v[80:83], v[92:95], 0
    v_cvt_pk_bf16_f32 v32, v32, v33
    v_cvt_pk_bf16_f32 v33, v34, v35
    v_cvt_pk_bf16_f32 v34, v36, v37
    v_cvt_pk_bf16_f32 v35, v38, v39
    v_exp_f32 v40, v40
    v_exp_f32 v41, v41
    v_mfma_f32_32x32x16_bf16 v[64:79], v[84:87], v[32:35], v[64:79]
    s_setprio 1
    s_mov_b64 exec, s[28:29]
    ds_read_b128 v[84:87], v13 offset:0
    s_mov_b64 exec, -1
    v_exp_f32 v42, v42
    v_exp_f32 v43, v43
    v_exp_f32 v44, v44
    v_exp_f32 v45, v45
    v_exp_f32 v46, v46
    v_exp_f32 v47, v47
    v_cvt_pk_bf16_f32 v40, v40, v41
    v_cvt_pk_bf16_f32 v41, v42, v43
    v_cvt_pk_bf16_f32 v42, v44, v45
    v_cvt_pk_bf16_f32 v43, v46, v47
    v_exp_f32 v16, v16
    v_exp_f32 v17, v17
    v_mfma_f32_32x32x16_bf16 v[64:79], v[88:91], v[40:43], v[64:79]
    s_mov_b64 exec, s[28:29]
    ds_read_b128 v[88:91], v13 offset:512
    s_mov_b64 exec, -1
    s_setprio 0
    v_exp_f32 v18, v18
    v_exp_f32 v19, v19
    v_exp_f32 v20, v20
    v_exp_f32 v21, v21
    v_exp_f32 v22, v22
    v_exp_f32 v23, v23
    v_mfma_f32_32x32x16_bf16 v[32:47], v[80:83], v[96:99], 0
    v_cvt_pk_bf16_f32 v16, v16, v17
    v_cvt_pk_bf16_f32 v17, v18, v19
    v_cvt_pk_bf16_f32 v18, v20, v21
    v_cvt_pk_bf16_f32 v19, v22, v23
    v_exp_f32 v24, v24
    v_exp_f32 v25, v25
    s_waitcnt lgkmcnt(0)
    v_mfma_f32_32x32x16_bf16 v[48:63], v[84:87], v[16:19], v[48:63]
    s_waitcnt vmcnt(8)
    s_barrier
    s_setprio 3
    ds_read_b128 v[80:83], v11 offset:9216
    s_add_u32 m0, s83, 0x16500
    s_add_u32 s79, s82, 0xd7000
    buffer_load_dwordx4 v240, s[44:47], s79 offen lds
    v_exp_f32 v26, v26
    v_exp_f32 v27, v27
    buffer_load_dwordx4 v241, s[44:47], s79 offen offset:1024 lds
    v_exp_f32 v28, v28
    v_exp_f32 v29, v29
    buffer_load_dwordx4 v244, s[44:47], s79 offen offset:2048 lds
    v_exp_f32 v30, v30
    v_exp_f32 v31, v31
    s_add_u32 m0, s83, 0x17100
    s_add_u32 s79, s82, 0xdc600
    buffer_load_dwordx4 v240, s[44:47], s79 offen lds
    v_cvt_pk_bf16_f32 v24, v24, v25
    v_cvt_pk_bf16_f32 v25, v26, v27
    v_cvt_pk_bf16_f32 v26, v28, v29
    v_cvt_pk_bf16_f32 v27, v30, v31
    v_exp_f32 v32, v32
    v_exp_f32 v33, v33
    v_mfma_f32_32x32x16_bf16 v[48:63], v[88:91], v[24:27], v[48:63]
    s_setprio 2
    buffer_load_dwordx4 v241, s[44:47], s79 offen offset:1024 lds
    v_exp_f32 v34, v34
    v_exp_f32 v35, v35
    buffer_load_dwordx4 v244, s[44:47], s79 offen offset:2048 lds
    v_exp_f32 v36, v36
    v_exp_f32 v37, v37
    v_exp_f32 v38, v38
    v_exp_f32 v39, v39
    s_waitcnt lgkmcnt(0)
    v_mfma_f32_32x32x16_bf16 v[16:31], v[80:83], v[92:95], 0
    v_cvt_pk_bf16_f32 v32, v32, v33
    v_cvt_pk_bf16_f32 v33, v34, v35
    v_cvt_pk_bf16_f32 v34, v36, v37
    v_cvt_pk_bf16_f32 v35, v38, v39
    v_exp_f32 v40, v40
    v_exp_f32 v41, v41
    v_mfma_f32_32x32x16_bf16 v[64:79], v[84:87], v[32:35], v[64:79]
    s_setprio 1
    s_mov_b64 exec, s[28:29]
    ds_read_b128 v[84:87], v13 offset:1024
    s_mov_b64 exec, -1
    v_exp_f32 v42, v42
    v_exp_f32 v43, v43
    v_exp_f32 v44, v44
    v_exp_f32 v45, v45
    v_exp_f32 v46, v46
    v_exp_f32 v47, v47
    v_cvt_pk_bf16_f32 v40, v40, v41
    v_cvt_pk_bf16_f32 v41, v42, v43
    v_cvt_pk_bf16_f32 v42, v44, v45
    v_cvt_pk_bf16_f32 v43, v46, v47
    v_exp_f32 v16, v16
    v_exp_f32 v17, v17
    v_mfma_f32_32x32x16_bf16 v[64:79], v[88:91], v[40:43], v[64:79]
    s_mov_b64 exec, s[28:29]
    ds_read_b128 v[88:91], v13 offset:1536
    s_mov_b64 exec, -1
    s_setprio 0
    v_exp_f32 v18, v18
    v_exp_f32 v19, v19
    v_exp_f32 v20, v20
    v_exp_f32 v21, v21
    v_exp_f32 v22, v22
    v_exp_f32 v23, v23
    v_mfma_f32_32x32x16_bf16 v[32:47], v[80:83], v[96:99], 0
    v_cvt_pk_bf16_f32 v16, v16, v17
    v_cvt_pk_bf16_f32 v17, v18, v19
    v_cvt_pk_bf16_f32 v18, v20, v21
    v_cvt_pk_bf16_f32 v19, v22, v23
    v_exp_f32 v24, v24
    v_exp_f32 v25, v25
    s_waitcnt lgkmcnt(0)
    v_mfma_f32_32x32x16_bf16 v[48:63], v[84:87], v[16:19], v[48:63]
    s_waitcnt vmcnt(12)
    s_waitcnt vmcnt(6)
    s_barrier
    s_setprio 3
    ds_read_b128 v[80:83], v11 offset:0
    s_add_u32 m0, s92, 0x2000
    s_add_u32 s78, s91, 10240
    buffer_load_dwordx4 v3, s[52:55], s78 offen sc1 lds
    s_add_u32 m0, s92, 0x1000
    s_sub_u32 s78, s78, 32768
    buffer_load_dwordx4 v3, s[52:55], s78 offen sc1 lds
    s_add_u32 m0, s83, 0x1c600
    s_add_u32 s79, s82, 0xec800
    buffer_load_dwordx4 v240, s[44:47], s79 offen lds
    v_exp_f32 v26, v26
    v_exp_f32 v27, v27
    buffer_load_dwordx4 v241, s[44:47], s79 offen offset:1024 lds
    v_exp_f32 v28, v28
    v_exp_f32 v29, v29
    buffer_load_dwordx4 v244, s[44:47], s79 offen offset:2048 lds
    v_exp_f32 v30, v30
    v_exp_f32 v31, v31
    s_add_u32 m0, s83, 0x1d200
    s_add_u32 s79, s82, 0xf1e00
    buffer_load_dwordx4 v240, s[44:47], s79 offen lds
    v_cvt_pk_bf16_f32 v24, v24, v25
    v_cvt_pk_bf16_f32 v25, v26, v27
    v_cvt_pk_bf16_f32 v26, v28, v29
    v_cvt_pk_bf16_f32 v27, v30, v31
    v_exp_f32 v32, v32
    v_exp_f32 v33, v33
    v_mfma_f32_32x32x16_bf16 v[48:63], v[88:91], v[24:27], v[48:63]
    s_setprio 2
    buffer_load_dwordx4 v241, s[44:47], s79 offen offset:1024 lds
    v_exp_f32 v34, v34
    v_exp_f32 v35, v35
    buffer_load_dwordx4 v244, s[44:47], s79 offen offset:2048 lds
    v_exp_f32 v36, v36
    v_exp_f32 v37, v37
    v_exp_f32 v38, v38
    v_exp_f32 v39, v39
    s_waitcnt lgkmcnt(0)
    v_mfma_f32_32x32x16_bf16 v[16:31], v[80:83], v[92:95], 0
    v_cvt_pk_bf16_f32 v32, v32, v33
    v_cvt_pk_bf16_f32 v33, v34, v35
    v_cvt_pk_bf16_f32 v34, v36, v37
    v_cvt_pk_bf16_f32 v35, v38, v39
    v_exp_f32 v40, v40
    v_exp_f32 v41, v41
    v_mfma_f32_32x32x16_bf16 v[64:79], v[84:87], v[32:35], v[64:79]
    s_setprio 1
    s_mov_b64 exec, s[28:29]
    ds_read_b128 v[84:87], v12 offset:0
    s_mov_b64 exec, -1
    v_exp_f32 v42, v42
    v_exp_f32 v43, v43
    v_exp_f32 v44, v44
    v_exp_f32 v45, v45
    v_exp_f32 v46, v46
    v_exp_f32 v47, v47
    v_cvt_pk_bf16_f32 v40, v40, v41
    v_cvt_pk_bf16_f32 v41, v42, v43
    v_cvt_pk_bf16_f32 v42, v44, v45
    v_cvt_pk_bf16_f32 v43, v46, v47
    v_exp_f32 v16, v16
    v_exp_f32 v17, v17
    v_mfma_f32_32x32x16_bf16 v[64:79], v[88:91], v[40:43], v[64:79]
    s_mov_b64 exec, s[28:29]
    ds_read_b128 v[88:91], v12 offset:512
    s_mov_b64 exec, -1
    s_setprio 0
    v_exp_f32 v18, v18
    v_exp_f32 v19, v19
    v_exp_f32 v20, v20
    v_exp_f32 v21, v21
    v_exp_f32 v22, v22
    v_exp_f32 v23, v23
    v_mfma_f32_32x32x16_bf16 v[32:47], v[80:83], v[96:99], 0
    v_cvt_pk_bf16_f32 v16, v16, v17
    v_cvt_pk_bf16_f32 v17, v18, v19
    v_cvt_pk_bf16_f32 v18, v20, v21
    v_cvt_pk_bf16_f32 v19, v22, v23
    v_exp_f32 v24, v24
    v_exp_f32 v25, v25
    s_waitcnt lgkmcnt(0)
    v_mfma_f32_32x32x16_bf16 v[48:63], v[84:87], v[16:19], v[48:63]
    s_waitcnt vmcnt(8)
    s_barrier
    s_setprio 3
    ds_read_b128 v[80:83], v11 offset:1024
    s_add_u32 m0, s83, 0x10400
    s_add_u32 s79, s82, 0x102000
    buffer_load_dwordx4 v240, s[44:47], s79 offen lds
    v_exp_f32 v26, v26
    v_exp_f32 v27, v27
    buffer_load_dwordx4 v241, s[44:47], s79 offen offset:1024 lds
    v_exp_f32 v28, v28
    v_exp_f32 v29, v29
    buffer_load_dwordx4 v244, s[44:47], s79 offen offset:2048 lds
    v_exp_f32 v30, v30
    v_exp_f32 v31, v31
    s_add_u32 m0, s83, 0x11000
    s_add_u32 s79, s82, 0x107600
    buffer_load_dwordx4 v240, s[44:47], s79 offen lds
    v_cvt_pk_bf16_f32 v24, v24, v25
    v_cvt_pk_bf16_f32 v25, v26, v27
    v_cvt_pk_bf16_f32 v26, v28, v29
    v_cvt_pk_bf16_f32 v27, v30, v31
    v_exp_f32 v32, v32
    v_exp_f32 v33, v33
    v_mfma_f32_32x32x16_bf16 v[48:63], v[88:91], v[24:27], v[48:63]
    s_setprio 2
    buffer_load_dwordx4 v241, s[44:47], s79 offen offset:1024 lds
    v_exp_f32 v34, v34
    v_exp_f32 v35, v35
    buffer_load_dwordx4 v244, s[44:47], s79 offen offset:2048 lds
    v_exp_f32 v36, v36
    v_exp_f32 v37, v37
    v_exp_f32 v38, v38
    v_exp_f32 v39, v39
    s_waitcnt lgkmcnt(0)
    v_mfma_f32_32x32x16_bf16 v[16:31], v[80:83], v[92:95], 0
    v_cvt_pk_bf16_f32 v32, v32, v33
    v_cvt_pk_bf16_f32 v33, v34, v35
    v_cvt_pk_bf16_f32 v34, v36, v37
    v_cvt_pk_bf16_f32 v35, v38, v39
    v_exp_f32 v40, v40
    v_exp_f32 v41, v41
    v_mfma_f32_32x32x16_bf16 v[64:79], v[84:87], v[32:35], v[64:79]
    s_setprio 1
    s_mov_b64 exec, s[28:29]
    ds_read_b128 v[84:87], v12 offset:1024
    s_mov_b64 exec, -1
    v_exp_f32 v42, v42
    v_exp_f32 v43, v43
    v_exp_f32 v44, v44
    v_exp_f32 v45, v45
    v_exp_f32 v46, v46
    v_exp_f32 v47, v47
    v_cvt_pk_bf16_f32 v40, v40, v41
    v_cvt_pk_bf16_f32 v41, v42, v43
    v_cvt_pk_bf16_f32 v42, v44, v45
    v_cvt_pk_bf16_f32 v43, v46, v47
    v_exp_f32 v16, v16
    v_exp_f32 v17, v17
    v_mfma_f32_32x32x16_bf16 v[64:79], v[88:91], v[40:43], v[64:79]
    s_mov_b64 exec, s[28:29]
    ds_read_b128 v[88:91], v12 offset:1536
    s_mov_b64 exec, -1
    s_setprio 0
    v_exp_f32 v18, v18
    v_exp_f32 v19, v19
    v_exp_f32 v20, v20
    v_exp_f32 v21, v21
    v_exp_f32 v22, v22
    v_exp_f32 v23, v23
    v_mfma_f32_32x32x16_bf16 v[32:47], v[80:83], v[96:99], 0
    v_cvt_pk_bf16_f32 v16, v16, v17
    v_cvt_pk_bf16_f32 v17, v18, v19
    v_cvt_pk_bf16_f32 v18, v20, v21
    v_cvt_pk_bf16_f32 v19, v22, v23
    v_exp_f32 v24, v24
    v_exp_f32 v25, v25
    s_waitcnt lgkmcnt(0)
    v_mfma_f32_32x32x16_bf16 v[48:63], v[84:87], v[16:19], v[48:63]
    s_waitcnt vmcnt(12)
    s_waitcnt vmcnt(6)
    s_barrier
    s_setprio 3
    ds_read_b128 v[80:83], v11 offset:8192
    s_mov_b32 m0, s92
    s_add_u32 s78, s91, 12288
    buffer_load_dwordx4 v3, s[52:55], s78 offen sc1 lds
    s_add_u32 m0, s92, 0xfffff000
    s_sub_u32 s78, s78, 32768
    buffer_load_dwordx4 v3, s[52:55], s78 offen sc1 lds
    s_add_u32 m0, s83, 0x16500
    s_add_u32 s79, s82, 0x117800
    buffer_load_dwordx4 v240, s[44:47], s79 offen lds
    v_exp_f32 v26, v26
    v_exp_f32 v27, v27
    buffer_load_dwordx4 v241, s[44:47], s79 offen offset:1024 lds
    v_exp_f32 v28, v28
    v_exp_f32 v29, v29
    buffer_load_dwordx4 v244, s[44:47], s79 offen offset:2048 lds
    v_exp_f32 v30, v30
    v_exp_f32 v31, v31
    s_add_u32 m0, s83, 0x17100
    s_add_u32 s79, s82, 0x11ce00
    buffer_load_dwordx4 v240, s[44:47], s79 offen lds
    v_cvt_pk_bf16_f32 v24, v24, v25
    v_cvt_pk_bf16_f32 v25, v26, v27
    v_cvt_pk_bf16_f32 v26, v28, v29
    v_cvt_pk_bf16_f32 v27, v30, v31
    v_exp_f32 v32, v32
    v_exp_f32 v33, v33
    v_mfma_f32_32x32x16_bf16 v[48:63], v[88:91], v[24:27], v[48:63]
    s_setprio 2
    buffer_load_dwordx4 v241, s[44:47], s79 offen offset:1024 lds
    v_exp_f32 v34, v34
    v_exp_f32 v35, v35
    buffer_load_dwordx4 v244, s[44:47], s79 offen offset:2048 lds
    v_exp_f32 v36, v36
    v_exp_f32 v37, v37
    v_exp_f32 v38, v38
    v_exp_f32 v39, v39
    s_waitcnt lgkmcnt(0)
    v_mfma_f32_32x32x16_bf16 v[16:31], v[80:83], v[92:95], 0
    v_cvt_pk_bf16_f32 v32, v32, v33
    v_cvt_pk_bf16_f32 v33, v34, v35
    v_cvt_pk_bf16_f32 v34, v36, v37
    v_cvt_pk_bf16_f32 v35, v38, v39
    v_exp_f32 v40, v40
    v_exp_f32 v41, v41
    v_mfma_f32_32x32x16_bf16 v[64:79], v[84:87], v[32:35], v[64:79]
    s_setprio 1
    s_mov_b64 exec, s[28:29]
    ds_read_b128 v[84:87], v13 offset:0
    s_mov_b64 exec, -1
    v_exp_f32 v42, v42
    v_exp_f32 v43, v43
    v_exp_f32 v44, v44
    v_exp_f32 v45, v45
    v_exp_f32 v46, v46
    v_exp_f32 v47, v47
    v_cvt_pk_bf16_f32 v40, v40, v41
    v_cvt_pk_bf16_f32 v41, v42, v43
    v_cvt_pk_bf16_f32 v42, v44, v45
    v_cvt_pk_bf16_f32 v43, v46, v47
    v_exp_f32 v16, v16
    v_exp_f32 v17, v17
    v_mfma_f32_32x32x16_bf16 v[64:79], v[88:91], v[40:43], v[64:79]
    s_mov_b64 exec, s[28:29]
    ds_read_b128 v[88:91], v13 offset:512
    s_mov_b64 exec, -1
    s_setprio 0
    v_exp_f32 v18, v18
    v_exp_f32 v19, v19
    v_exp_f32 v20, v20
    v_exp_f32 v21, v21
    v_exp_f32 v22, v22
    v_exp_f32 v23, v23
    v_mfma_f32_32x32x16_bf16 v[32:47], v[80:83], v[96:99], 0
    v_cvt_pk_bf16_f32 v16, v16, v17
    v_cvt_pk_bf16_f32 v17, v18, v19
    v_cvt_pk_bf16_f32 v18, v20, v21
    v_cvt_pk_bf16_f32 v19, v22, v23
    v_exp_f32 v24, v24
    v_exp_f32 v25, v25
    s_waitcnt lgkmcnt(0)
    v_mfma_f32_32x32x16_bf16 v[48:63], v[84:87], v[16:19], v[48:63]
    s_waitcnt vmcnt(8)
    s_barrier
    s_setprio 3
    ds_read_b128 v[80:83], v11 offset:9216
    s_add_u32 m0, s83, 0x1c600
    s_add_u32 s79, s82, 0x12d000
    buffer_load_dwordx4 v240, s[44:47], s79 offen lds
    v_exp_f32 v26, v26
    v_exp_f32 v27, v27
    buffer_load_dwordx4 v241, s[44:47], s79 offen offset:1024 lds
    v_exp_f32 v28, v28
    v_exp_f32 v29, v29
    buffer_load_dwordx4 v244, s[44:47], s79 offen offset:2048 lds
    v_exp_f32 v30, v30
    v_exp_f32 v31, v31
    s_add_u32 m0, s83, 0x1d200
    s_add_u32 s79, s82, 0x132600
    buffer_load_dwordx4 v240, s[44:47], s79 offen lds
    v_cvt_pk_bf16_f32 v24, v24, v25
    v_cvt_pk_bf16_f32 v25, v26, v27
    v_cvt_pk_bf16_f32 v26, v28, v29
    v_cvt_pk_bf16_f32 v27, v30, v31
    v_exp_f32 v32, v32
    v_exp_f32 v33, v33
    v_mfma_f32_32x32x16_bf16 v[48:63], v[88:91], v[24:27], v[48:63]
    s_setprio 2
    buffer_load_dwordx4 v241, s[44:47], s79 offen offset:1024 lds
    v_exp_f32 v34, v34
    v_exp_f32 v35, v35
    buffer_load_dwordx4 v244, s[44:47], s79 offen offset:2048 lds
    v_exp_f32 v36, v36
    v_exp_f32 v37, v37
    v_exp_f32 v38, v38
    v_exp_f32 v39, v39
    s_waitcnt lgkmcnt(0)
    v_mfma_f32_32x32x16_bf16 v[16:31], v[80:83], v[92:95], 0
    v_cvt_pk_bf16_f32 v32, v32, v33
    v_cvt_pk_bf16_f32 v33, v34, v35
    v_cvt_pk_bf16_f32 v34, v36, v37
    v_cvt_pk_bf16_f32 v35, v38, v39
    v_exp_f32 v40, v40
    v_exp_f32 v41, v41
    v_mfma_f32_32x32x16_bf16 v[64:79], v[84:87], v[32:35], v[64:79]
    s_setprio 1
    s_mov_b64 exec, s[28:29]
    ds_read_b128 v[84:87], v13 offset:1024
    s_mov_b64 exec, -1
    v_exp_f32 v42, v42
    v_exp_f32 v43, v43
    v_exp_f32 v44, v44
    v_exp_f32 v45, v45
    v_exp_f32 v46, v46
    v_exp_f32 v47, v47
    v_cvt_pk_bf16_f32 v40, v40, v41
    v_cvt_pk_bf16_f32 v41, v42, v43
    v_cvt_pk_bf16_f32 v42, v44, v45
    v_cvt_pk_bf16_f32 v43, v46, v47
    v_exp_f32 v16, v16
    v_exp_f32 v17, v17
    v_mfma_f32_32x32x16_bf16 v[64:79], v[88:91], v[40:43], v[64:79]
    s_mov_b64 exec, s[28:29]
    ds_read_b128 v[88:91], v13 offset:1536
    s_mov_b64 exec, -1
    s_setprio 0
    v_exp_f32 v18, v18
    v_exp_f32 v19, v19
    v_exp_f32 v20, v20
    v_exp_f32 v21, v21
    v_exp_f32 v22, v22
    v_exp_f32 v23, v23
    v_mfma_f32_32x32x16_bf16 v[32:47], v[80:83], v[96:99], 0
    v_cvt_pk_bf16_f32 v16, v16, v17
    v_cvt_pk_bf16_f32 v17, v18, v19
    v_cvt_pk_bf16_f32 v18, v20, v21
    v_cvt_pk_bf16_f32 v19, v22, v23
    v_exp_f32 v24, v24
    v_exp_f32 v25, v25
    s_waitcnt lgkmcnt(0)
    v_mfma_f32_32x32x16_bf16 v[48:63], v[84:87], v[16:19], v[48:63]
    s_waitcnt vmcnt(12)
    s_waitcnt vmcnt(6)
    s_barrier
    s_setprio 3
    ds_read_b128 v[80:83], v11 offset:0
    s_add_u32 m0, s92, 0x2000
    s_add_u32 s78, s91, 14336
    buffer_load_dwordx4 v3, s[52:55], s78 offen sc1 lds
    s_add_u32 m0, s92, 0x1000
    s_sub_u32 s78, s78, 32768
    buffer_load_dwordx4 v3, s[52:55], s78 offen sc1 lds
    s_add_u32 m0, s83, 0x10400
    s_add_u32 s79, s82, 0x142800
    buffer_load_dwordx4 v240, s[44:47], s79 offen lds
    v_exp_f32 v26, v26
    v_exp_f32 v27, v27
    buffer_load_dwordx4 v241, s[44:47], s79 offen offset:1024 lds
    v_exp_f32 v28, v28
    v_exp_f32 v29, v29
    buffer_load_dwordx4 v244, s[44:47], s79 offen offset:2048 lds
    v_exp_f32 v30, v30
    v_exp_f32 v31, v31
    s_add_u32 m0, s83, 0x11000
    s_add_u32 s79, s82, 0x147e00
    buffer_load_dwordx4 v240, s[44:47], s79 offen lds
    v_cvt_pk_bf16_f32 v24, v24, v25
    v_cvt_pk_bf16_f32 v25, v26, v27
    v_cvt_pk_bf16_f32 v26, v28, v29
    v_cvt_pk_bf16_f32 v27, v30, v31
    v_exp_f32 v32, v32
    v_exp_f32 v33, v33
    v_mfma_f32_32x32x16_bf16 v[48:63], v[88:91], v[24:27], v[48:63]
    s_setprio 2
    buffer_load_dwordx4 v241, s[44:47], s79 offen offset:1024 lds
    v_exp_f32 v34, v34
    v_exp_f32 v35, v35
    buffer_load_dwordx4 v244, s[44:47], s79 offen offset:2048 lds
    v_exp_f32 v36, v36
    v_exp_f32 v37, v37
    v_exp_f32 v38, v38
    v_exp_f32 v39, v39
    s_waitcnt lgkmcnt(0)
    v_mfma_f32_32x32x16_bf16 v[16:31], v[80:83], v[92:95], 0
    v_cvt_pk_bf16_f32 v32, v32, v33
    v_cvt_pk_bf16_f32 v33, v34, v35
    v_cvt_pk_bf16_f32 v34, v36, v37
    v_cvt_pk_bf16_f32 v35, v38, v39
    v_exp_f32 v40, v40
    v_exp_f32 v41, v41
    v_mfma_f32_32x32x16_bf16 v[64:79], v[84:87], v[32:35], v[64:79]
    s_setprio 1
    s_mov_b64 exec, s[28:29]
    ds_read_b128 v[84:87], v12 offset:0
    s_mov_b64 exec, -1
    v_exp_f32 v42, v42
    v_exp_f32 v43, v43
    v_exp_f32 v44, v44
    v_exp_f32 v45, v45
    v_exp_f32 v46, v46
    v_exp_f32 v47, v47
    v_cvt_pk_bf16_f32 v40, v40, v41
    v_cvt_pk_bf16_f32 v41, v42, v43
    v_cvt_pk_bf16_f32 v42, v44, v45
    v_cvt_pk_bf16_f32 v43, v46, v47
    v_exp_f32 v16, v16
    v_exp_f32 v17, v17
    v_mfma_f32_32x32x16_bf16 v[64:79], v[88:91], v[40:43], v[64:79]
    s_mov_b64 exec, s[28:29]
    ds_read_b128 v[88:91], v12 offset:512
    s_mov_b64 exec, -1
    s_setprio 0
    v_exp_f32 v18, v18
    v_exp_f32 v19, v19
    v_exp_f32 v20, v20
    v_exp_f32 v21, v21
    v_exp_f32 v22, v22
    v_exp_f32 v23, v23
    v_mfma_f32_32x32x16_bf16 v[32:47], v[80:83], v[96:99], 0
    v_cvt_pk_bf16_f32 v16, v16, v17
    v_cvt_pk_bf16_f32 v17, v18, v19
    v_cvt_pk_bf16_f32 v18, v20, v21
    v_cvt_pk_bf16_f32 v19, v22, v23
    v_exp_f32 v24, v24
    v_exp_f32 v25, v25
    s_waitcnt lgkmcnt(0)
    v_mfma_f32_32x32x16_bf16 v[48:63], v[84:87], v[16:19], v[48:63]
    s_waitcnt vmcnt(8)
    s_barrier
    s_setprio 3
    ds_read_b128 v[80:83], v11 offset:1024
    v_exp_f32 v26, v26
    v_exp_f32 v27, v27
    v_exp_f32 v28, v28
    v_exp_f32 v29, v29
    v_exp_f32 v30, v30
    v_exp_f32 v31, v31
    v_cvt_pk_bf16_f32 v24, v24, v25
    v_cvt_pk_bf16_f32 v25, v26, v27
    v_cvt_pk_bf16_f32 v26, v28, v29
    v_cvt_pk_bf16_f32 v27, v30, v31
    v_exp_f32 v32, v32
    v_exp_f32 v33, v33
    v_mfma_f32_32x32x16_bf16 v[48:63], v[88:91], v[24:27], v[48:63]
    s_setprio 2
    v_exp_f32 v34, v34
    v_exp_f32 v35, v35
    v_exp_f32 v36, v36
    v_exp_f32 v37, v37
    v_exp_f32 v38, v38
    v_exp_f32 v39, v39
    s_waitcnt lgkmcnt(0)
    v_mfma_f32_32x32x16_bf16 v[16:31], v[80:83], v[92:95], 0
    v_cvt_pk_bf16_f32 v32, v32, v33
    v_cvt_pk_bf16_f32 v33, v34, v35
    v_cvt_pk_bf16_f32 v34, v36, v37
    v_cvt_pk_bf16_f32 v35, v38, v39
    v_exp_f32 v40, v40
    v_exp_f32 v41, v41
    v_mfma_f32_32x32x16_bf16 v[64:79], v[84:87], v[32:35], v[64:79]
    s_setprio 1
    s_mov_b64 exec, s[28:29]
    ds_read_b128 v[84:87], v12 offset:1024
    s_mov_b64 exec, -1
    v_exp_f32 v42, v42
    v_exp_f32 v43, v43
    v_exp_f32 v44, v44
    v_exp_f32 v45, v45
    v_exp_f32 v46, v46
    v_exp_f32 v47, v47
    v_cvt_pk_bf16_f32 v40, v40, v41
    v_cvt_pk_bf16_f32 v41, v42, v43
    v_cvt_pk_bf16_f32 v42, v44, v45
    v_cvt_pk_bf16_f32 v43, v46, v47
    v_exp_f32 v16, v16
    v_exp_f32 v17, v17
    v_mfma_f32_32x32x16_bf16 v[64:79], v[88:91], v[40:43], v[64:79]
    s_mov_b64 exec, s[28:29]
    ds_read_b128 v[88:91], v12 offset:1536
    s_mov_b64 exec, -1
    s_setprio 0
    v_exp_f32 v18, v18
    v_exp_f32 v19, v19
    v_exp_f32 v20, v20
    v_exp_f32 v21, v21
    v_exp_f32 v22, v22
    v_exp_f32 v23, v23
    v_mfma_f32_32x32x16_bf16 v[32:47], v[80:83], v[96:99], 0
    v_cvt_pk_bf16_f32 v16, v16, v17
    v_cvt_pk_bf16_f32 v17, v18, v19
    v_cvt_pk_bf16_f32 v18, v20, v21
    v_cvt_pk_bf16_f32 v19, v22, v23
    v_exp_f32 v24, v24
    v_exp_f32 v25, v25
    s_waitcnt lgkmcnt(0)
    v_mfma_f32_32x32x16_bf16 v[48:63], v[84:87], v[16:19], v[48:63]
    s_waitcnt vmcnt(6)
    s_waitcnt vmcnt(0)
    s_barrier
    s_setprio 3
    ds_read_b128 v[80:83], v11 offset:8192
    s_mov_b32 m0, s92
    s_add_u32 s78, s91, 16384
    buffer_load_dwordx4 v3, s[52:55], s78 offen sc1 lds
    s_add_u32 m0, s92, 0xfffff000
    s_sub_u32 s78, s78, 32768
    buffer_load_dwordx4 v3, s[52:55], s78 offen sc1 lds
    v_exp_f32 v26, v26
    v_exp_f32 v27, v27
    v_exp_f32 v28, v28
    v_exp_f32 v29, v29
    v_exp_f32 v30, v30
    v_exp_f32 v31, v31
    v_cvt_pk_bf16_f32 v24, v24, v25
    v_cvt_pk_bf16_f32 v25, v26, v27
    v_cvt_pk_bf16_f32 v26, v28, v29
    v_cvt_pk_bf16_f32 v27, v30, v31
    v_exp_f32 v32, v32
    v_exp_f32 v33, v33
    v_mfma_f32_32x32x16_bf16 v[48:63], v[88:91], v[24:27], v[48:63]
    s_setprio 2
    v_exp_f32 v34, v34
    v_exp_f32 v35, v35
    v_exp_f32 v36, v36
    v_exp_f32 v37, v37
    v_exp_f32 v38, v38
    v_exp_f32 v39, v39
    s_waitcnt lgkmcnt(0)
    v_mfma_f32_32x32x16_bf16 v[16:31], v[80:83], v[92:95], 0
    v_cvt_pk_bf16_f32 v32, v32, v33
    v_cvt_pk_bf16_f32 v33, v34, v35
    v_cvt_pk_bf16_f32 v34, v36, v37
    v_cvt_pk_bf16_f32 v35, v38, v39
    v_exp_f32 v40, v40
    v_exp_f32 v41, v41
    v_mfma_f32_32x32x16_bf16 v[64:79], v[84:87], v[32:35], v[64:79]
    s_setprio 1
    s_mov_b64 exec, s[28:29]
    ds_read_b128 v[84:87], v13 offset:0
    s_mov_b64 exec, -1
    v_exp_f32 v42, v42
    v_exp_f32 v43, v43
    v_exp_f32 v44, v44
    v_exp_f32 v45, v45
    v_exp_f32 v46, v46
    v_exp_f32 v47, v47
    v_cvt_pk_bf16_f32 v40, v40, v41
    v_cvt_pk_bf16_f32 v41, v42, v43
    v_cvt_pk_bf16_f32 v42, v44, v45
    v_cvt_pk_bf16_f32 v43, v46, v47
    v_exp_f32 v16, v16
    v_exp_f32 v17, v17
    v_mfma_f32_32x32x16_bf16 v[64:79], v[88:91], v[40:43], v[64:79]
    s_mov_b64 exec, s[28:29]
    ds_read_b128 v[88:91], v13 offset:512
    s_mov_b64 exec, -1
    s_setprio 0
    v_exp_f32 v18, v18
    v_exp_f32 v19, v19
    v_exp_f32 v20, v20
    v_exp_f32 v21, v21
    v_exp_f32 v22, v22
    v_exp_f32 v23, v23
    v_mfma_f32_32x32x16_bf16 v[32:47], v[80:83], v[96:99], 0
    v_cvt_pk_bf16_f32 v16, v16, v17
    v_cvt_pk_bf16_f32 v17, v18, v19
    v_cvt_pk_bf16_f32 v18, v20, v21
    v_cvt_pk_bf16_f32 v19, v22, v23
    v_exp_f32 v24, v24
    v_exp_f32 v25, v25
    s_waitcnt lgkmcnt(0)
    v_mfma_f32_32x32x16_bf16 v[48:63], v[84:87], v[16:19], v[48:63]
    s_barrier
    s_setprio 0
    ds_read_b128 v[80:83], v11 offset:9216
    s_mov_b32 m0, s15
    s_add_u32 s78, s12, 0x0
    buffer_load_dwordx4 v8, s[64:67], s78 offen lds
    v_exp_f32 v26, v26
    v_exp_f32 v27, v27
    s_add_u32 m0, s15, 0x400
    s_add_u32 s78, s12, 0x2000
    buffer_load_dwordx4 v8, s[64:67], s78 offen lds
    v_exp_f32 v28, v28
    v_exp_f32 v29, v29
    s_add_u32 m0, s15, 0xffffe000
    s_add_u32 s78, s12, 0xffff0000
    buffer_load_dwordx4 v8, s[64:67], s78 offen lds
    v_exp_f32 v30, v30
    v_exp_f32 v31, v31
    s_add_u32 m0, s15, 0xffffe400
    s_add_u32 s78, s12, 0xffff2000
    buffer_load_dwordx4 v8, s[64:67], s78 offen lds
    v_cvt_pk_bf16_f32 v24, v24, v25
    v_cvt_pk_bf16_f32 v25, v26, v27
    v_cvt_pk_bf16_f32 v26, v28, v29
    v_cvt_pk_bf16_f32 v27, v30, v31
    v_exp_f32 v32, v32
    v_exp_f32 v33, v33
    v_mfma_f32_32x32x16_bf16 v[48:63], v[88:91], v[24:27], v[48:63]
    s_setprio 2
    s_add_u32 m0, s15, 0x4000
    s_add_u32 s78, s12, 0x20000
    buffer_load_dwordx4 v8, s[64:67], s78 offen lds
    v_exp_f32 v34, v34
    v_exp_f32 v35, v35
    s_add_u32 m0, s15, 0x4400
    s_add_u32 s78, s12, 0x22000
    buffer_load_dwordx4 v8, s[64:67], s78 offen lds
    v_exp_f32 v36, v36
    v_exp_f32 v37, v37
    s_add_u32 m0, s15, 0x2000
    s_add_u32 s78, s12, 0x10000
    buffer_load_dwordx4 v8, s[64:67], s78 offen lds
    v_exp_f32 v38, v38
    v_exp_f32 v39, v39
    s_waitcnt lgkmcnt(0)
    v_mfma_f32_32x32x16_bf16 v[16:31], v[80:83], v[92:95], 0
    s_add_u32 m0, s15, 0x2400
    s_add_u32 s78, s12, 0x12000
    buffer_load_dwordx4 v8, s[64:67], s78 offen lds
    v_cvt_pk_bf16_f32 v32, v32, v33
    v_cvt_pk_bf16_f32 v33, v34, v35
    v_cvt_pk_bf16_f32 v34, v36, v37
    v_cvt_pk_bf16_f32 v35, v38, v39
    s_add_u32 m0, s15, 0x8000
    s_add_u32 s78, s12, 0x40000
    buffer_load_dwordx4 v8, s[64:67], s78 offen lds
    v_exp_f32 v40, v40
    v_exp_f32 v41, v41
    v_mfma_f32_32x32x16_bf16 v[64:79], v[84:87], v[32:35], v[64:79]
    s_setprio 0
    s_mov_b64 exec, s[28:29]
    ds_read_b128 v[84:87], v13 offset:1024
    s_mov_b64 exec, -1
    s_add_u32 m0, s15, 0x8400
    s_add_u32 s78, s12, 0x42000
    buffer_load_dwordx4 v8, s[64:67], s78 offen lds
    v_exp_f32 v42, v42
    v_exp_f32 v43, v43
    s_add_u32 m0, s15, 0x6000
    s_add_u32 s78, s12, 0x30000
    buffer_load_dwordx4 v8, s[64:67], s78 offen lds
    v_exp_f32 v44, v44
    v_exp_f32 v45, v45
    s_add_u32 m0, s15, 0x6400
    s_add_u32 s78, s12, 0x32000
    buffer_load_dwordx4 v8, s[64:67], s78 offen lds
    v_exp_f32 v46, v46
    v_exp_f32 v47, v47
    s_add_u32 m0, s15, 0xc000
    s_add_u32 s78, s12, 0x60000
    buffer_load_dwordx4 v8, s[64:67], s78 offen lds
    v_cvt_pk_bf16_f32 v40, v40, v41
    v_cvt_pk_bf16_f32 v41, v42, v43
    v_cvt_pk_bf16_f32 v42, v44, v45
    v_cvt_pk_bf16_f32 v43, v46, v47
    v_exp_f32 v16, v16
    v_exp_f32 v17, v17
    v_mfma_f32_32x32x16_bf16 v[64:79], v[88:91], v[40:43], v[64:79]
    s_mov_b64 exec, s[28:29]
    ds_read_b128 v[88:91], v13 offset:1536
    s_mov_b64 exec, -1
    s_add_u32 m0, s15, 0xc400
    s_add_u32 s78, s12, 0x62000
    buffer_load_dwordx4 v8, s[64:67], s78 offen lds
    v_exp_f32 v18, v18
    v_exp_f32 v19, v19
    s_add_u32 m0, s15, 0xa000
    s_add_u32 s78, s12, 0x50000
    buffer_load_dwordx4 v8, s[64:67], s78 offen lds
    v_exp_f32 v20, v20
    v_exp_f32 v21, v21
    s_add_u32 m0, s15, 0xa400
    s_add_u32 s78, s12, 0x52000
    buffer_load_dwordx4 v8, s[64:67], s78 offen lds
    v_exp_f32 v22, v22
    v_exp_f32 v23, v23
    v_mfma_f32_32x32x16_bf16 v[32:47], v[80:83], v[96:99], 0
    v_cvt_pk_bf16_f32 v16, v16, v17
    v_cvt_pk_bf16_f32 v17, v18, v19
    v_cvt_pk_bf16_f32 v18, v20, v21
    v_cvt_pk_bf16_f32 v19, v22, v23
    v_exp_f32 v24, v24
    v_exp_f32 v25, v25
    s_waitcnt lgkmcnt(0)
    v_mfma_f32_32x32x16_bf16 v[48:63], v[84:87], v[16:19], v[48:63]
    s_waitcnt vmcnt(16)
    s_barrier
    s_setprio 0
    ds_read_b128 v[80:83], v11 offset:0
    s_add_u32 m0, s92, 0x2000
    s_add_u32 s78, s91, 18432
    buffer_load_dwordx4 v3, s[52:55], s78 offen sc1 lds
    s_add_u32 m0, s92, 0x1000
    s_sub_u32 s78, s78, 32768
    buffer_load_dwordx4 v3, s[52:55], s78 offen sc1 lds
    v_exp_f32 v26, v26
    v_exp_f32 v27, v27
    v_exp_f32 v28, v28
    v_exp_f32 v29, v29
    v_exp_f32 v30, v30
    v_exp_f32 v31, v31
    v_cvt_pk_bf16_f32 v24, v24, v25
    v_cvt_pk_bf16_f32 v25, v26, v27
    v_cvt_pk_bf16_f32 v26, v28, v29
    v_cvt_pk_bf16_f32 v27, v30, v31
    v_exp_f32 v32, v32
    v_exp_f32 v33, v33
    v_mfma_f32_32x32x16_bf16 v[48:63], v[88:91], v[24:27], v[48:63]
    v_exp_f32 v34, v34
    v_exp_f32 v35, v35
    v_exp_f32 v36, v36
    v_exp_f32 v37, v37
    v_exp_f32 v38, v38
    v_exp_f32 v39, v39
    s_waitcnt lgkmcnt(0)
    v_mfma_f32_32x32x16_bf16 v[16:31], v[80:83], v[92:95], 0
    v_cvt_pk_bf16_f32 v32, v32, v33
    v_cvt_pk_bf16_f32 v33, v34, v35
    v_cvt_pk_bf16_f32 v34, v36, v37
    v_cvt_pk_bf16_f32 v35, v38, v39
    v_exp_f32 v40, v40
    v_exp_f32 v41, v41
    v_mfma_f32_32x32x16_bf16 v[64:79], v[84:87], v[32:35], v[64:79]
    s_setprio 0
    s_mov_b64 exec, s[28:29]
    ds_read_b128 v[84:87], v12 offset:0
    s_mov_b64 exec, -1
    v_exp_f32 v42, v42
    v_exp_f32 v43, v43
    v_exp_f32 v44, v44
    v_exp_f32 v45, v45
    v_exp_f32 v46, v46
    v_exp_f32 v47, v47
    v_cvt_pk_bf16_f32 v40, v40, v41
    v_cvt_pk_bf16_f32 v41, v42, v43
    v_cvt_pk_bf16_f32 v42, v44, v45
    v_cvt_pk_bf16_f32 v43, v46, v47
    s_waitcnt lgkmcnt(0)
    s_nop 3
LF_join:
    v_lshrrev_b32 v6, 5, v2
    v_mul_u32_u24 v170, 4, v6
    v_bfe_u32 v6, v2, 2, 2
    v_add_u32 v170, v170, v6
    v_lshlrev_b32 v170, 7, v170
    v_lshlrev_b32 v6, 1, v6
    v_and_b32 v6, 4, v6
    v_bfe_u32 v7, v2, 4, 1
    v_lshlrev_b32 v7, 1, v7
    v_xor_b32 v6, v6, v7
    v_bfe_u32 v7, v2, 1, 1
    v_xor_b32 v6, v6, v7
    s_lshl_b32 s76, s31, 2
    v_xor_b32 v6, s76, v6
    v_lshl_add_u32 v170, v6, 4, v170
    v_and_b32 v6, 1, v2
    v_lshl_add_u32 v170, v6, 3, v170
    v_add_u32 v170, 0x0, v170
    s_lshl_b32 s77, s30, 5
    v_xor_b32 v170, s77, v170
    s_lshr_b32 s76, s72, 1
    s_lshl_b32 s77, s76, 11
    v_add_u32 v170, s77, v170
    v_xor_b32 v172, 64, v170
    v_add_u32 v171, 0x10000, v170
    v_add_u32 v173, 0x10000, v172
    s_mul_i32 s13, s86, 118
    s_add_u32 s13, s13, s76
    s_lshl_b32 s13, s13, 10
    s_add_u32 s13, s13, 0x400000
    v_lshlrev_b32 v14, 2, v2
    v_lshrrev_b32 v6, 3, v2
    v_mul_u32_u24 v6, 96, v6
    v_add_u32 v174, v6, v14
    s_lshl_b32 s76, s75, 8
    s_add_u32 s76, s76, 0x27300
    v_add_u32 v6, s76, v14
    ds_read_b32 v168, v6
    ds_read_b32 v169, v6 offset:512
    s_waitcnt lgkmcnt(0)
    v_add_f32 v168, v168, v169
    v_mov_b32 v169, v168
    s_nop 1
    v_permlane32_swap_b32 v168, v169
    v_add_f32 v168, v168, v169
    v_mul_f32 v6, 0xbfb8aa3b, v168
    v_exp_f32 v6, v6
    s_nop 0
    v_add_f32 v6, 1.0, v6
    v_rcp_f32 v15, v6
    s_mul_i32 s77, s72, 6144
    v_add_u32 v176, s77, v3
    s_xor_b32 s76, s72, 2
    s_mul_i32 s77, s76, 6144
    v_add_u32 v168, s77, v3
    s_xor_b32 s76, s72, 4
    s_mul_i32 s77, s76, 6144
    v_add_u32 v169, s77, v3
    s_xor_b32 s76, s72, 6
    s_mul_i32 s77, s76, 6144
    v_add_u32 v175, s77, v3
    v_and_b32 v177, 31, v2
    v_lshlrev_b32 v177, 10, v177
    v_lshrrev_b32 v7, 5, v2
    v_lshl_add_u32 v177, v7, 4, v177
    s_lshl_b32 s11, s86, 15
    s_lshl_b32 s77, s73, 7
    s_add_u32 s11, s11, s77
    s_lshl_b32 s77, s31, 6
    s_add_u32 s11, s11, s77
    s_lshl_b32 s77, s30, 5
    s_add_u32 s11, s11, s77
    v_lshlrev_b32 v179, 10, v2
    s_lshr_b32 s77, s72, 1
    s_mul_i32 s77, s77, 14336
    s_add_u32 s77, s77, 49152
    v_add_u32 v180, s77, v170
    v_add_u32 v181, s77, v172
    s_mul_i32 s76, s72, 3072
    s_add_u32 s76, s76, 114688
    v_add_u32 v182, s76, v3
    s_xor_b32 s76, s72, 4
    s_mul_i32 s76, s76, 3072
    s_add_u32 s76, s76, 114688
    v_add_u32 v183, s76, v3
    s_add_u32 s18, s10, 4096
    v_exp_f32 v16, v16
    v_exp_f32 v17, v17
    v_mfma_f32_32x32x16_bf16 v[64:79], v[88:91], v[40:43], v[64:79]
    s_mov_b64 exec, s[28:29]
    ds_read_b128 v[88:91], v12 offset:512
    s_mov_b64 exec, -1
    v_exp_f32 v18, v18
    v_exp_f32 v19, v19
    v_exp_f32 v20, v20
    v_exp_f32 v21, v21
    v_exp_f32 v22, v22
    v_exp_f32 v23, v23
    v_cvt_pk_bf16_f32 v16, v16, v17
    v_cvt_pk_bf16_f32 v17, v18, v19
    v_cvt_pk_bf16_f32 v18, v20, v21
    v_cvt_pk_bf16_f32 v19, v22, v23
    v_mfma_f32_32x32x16_bf16 v[32:47], v[80:83], v[96:99], 0
    v_exp_f32 v24, v24
    v_exp_f32 v25, v25
    v_exp_f32 v26, v26
    v_exp_f32 v27, v27
    v_mfma_f32_32x32x16_bf16 v[48:63], v[84:87], v[16:19], v[48:63]
    s_setprio 1
    ds_read_b128 v[80:83], v11 offset:1024
    v_exp_f32 v28, v28
    v_exp_f32 v29, v29
    v_exp_f32 v30, v30
    v_exp_f32 v31, v31
    v_cvt_pk_bf16_f32 v24, v24, v25
    v_cvt_pk_bf16_f32 v25, v26, v27
    v_cvt_pk_bf16_f32 v26, v28, v29
    v_cvt_pk_bf16_f32 v27, v30, v31
    v_exp_f32 v32, v32
    v_exp_f32 v33, v33
    s_waitcnt lgkmcnt(0)
    v_mfma_f32_32x32x16_bf16 v[48:63], v[88:91], v[24:27], v[48:63]
    v_exp_f32 v34, v34
    v_exp_f32 v35, v35
    v_exp_f32 v36, v36
    v_exp_f32 v37, v37
    v_exp_f32 v38, v38
    v_exp_f32 v39, v39
    v_cvt_pk_bf16_f32 v32, v32, v33
    v_cvt_pk_bf16_f32 v33, v34, v35
    v_cvt_pk_bf16_f32 v34, v36, v37
    v_cvt_pk_bf16_f32 v35, v38, v39
    v_mfma_f32_32x32x16_bf16 v[16:31], v[80:83], v[92:95], 0
    v_exp_f32 v40, v40
    v_exp_f32 v41, v41
    v_exp_f32 v42, v42
    v_exp_f32 v43, v43
    v_mfma_f32_32x32x16_bf16 v[64:79], v[84:87], v[32:35], v[64:79]
    s_setprio 0
    s_mov_b64 exec, s[28:29]
    ds_read_b128 v[84:87], v12 offset:1024
    s_mov_b64 exec, -1
    v_exp_f32 v44, v44
    v_exp_f32 v45, v45
    v_exp_f32 v46, v46
    v_exp_f32 v47, v47
    v_cvt_pk_bf16_f32 v40, v40, v41
    v_cvt_pk_bf16_f32 v41, v42, v43
    v_cvt_pk_bf16_f32 v42, v44, v45
    v_cvt_pk_bf16_f32 v43, v46, v47
    v_exp_f32 v16, v16
    v_exp_f32 v17, v17
    v_mfma_f32_32x32x16_bf16 v[64:79], v[88:91], v[40:43], v[64:79]
    s_mov_b64 exec, s[28:29]
    ds_read_b128 v[88:91], v12 offset:1536
    s_mov_b64 exec, -1
    v_exp_f32 v18, v18
    v_exp_f32 v19, v19
    v_exp_f32 v20, v20
    v_exp_f32 v21, v21
    v_exp_f32 v22, v22
    v_exp_f32 v23, v23
    v_cvt_pk_bf16_f32 v16, v16, v17
    v_cvt_pk_bf16_f32 v17, v18, v19
    v_cvt_pk_bf16_f32 v18, v20, v21
    v_cvt_pk_bf16_f32 v19, v22, v23
    v_mfma_f32_32x32x16_bf16 v[32:47], v[80:83], v[96:99], 0
    v_exp_f32 v24, v24
    v_exp_f32 v25, v25
    v_exp_f32 v26, v26
    v_exp_f32 v27, v27
    s_waitcnt lgkmcnt(0)
    v_mfma_f32_32x32x16_bf16 v[48:63], v[84:87], v[16:19], v[48:63]
    s_waitcnt vmcnt(0)
    s_barrier
    s_setprio 3
    ds_read_b128 v[80:83], v11 offset:8192
    s_mov_b32 m0, s92
    s_add_u32 s78, s91, 20480
    buffer_load_dwordx4 v3, s[52:55], s78 offen sc1 lds
    v_readfirstlane_b32 s93, v10
    s_nop 0
    s_cmp_lg_u32 s93, 0
    s_cbranch_scc1 LR3
    s_mov_b32 s90, 0
LS3_l:
    s_sleep 2
    buffer_load_dword v10, v9, s[68:71], 0 offen sc1
    s_waitcnt vmcnt(0)
    v_readfirstlane_b32 s93, v10
    s_add_u32 s90, s90, 1
    s_cmp_ge_u32 s90, 0x400000
    s_cbranch_scc1 LR3
    s_cmp_eq_u32 s93, 0
    s_cbranch_scc1 LS3_l
LR3:
    s_nop 0
    v_mov_b32 v6, s93
    s_mov_b64 exec, 1
    buffer_store_dword v6, v9, s[52:55], s7 offen sc1
    s_mov_b64 exec, -1
    v_exp_f32 v28, v28
    v_exp_f32 v29, v29
    v_exp_f32 v30, v30
    v_exp_f32 v31, v31
    v_cvt_pk_bf16_f32 v24, v24, v25
    v_cvt_pk_bf16_f32 v25, v26, v27
    v_cvt_pk_bf16_f32 v26, v28, v29
    v_cvt_pk_bf16_f32 v27, v30, v31
    v_exp_f32 v32, v32
    v_exp_f32 v33, v33
    v_mfma_f32_32x32x16_bf16 v[48:63], v[88:91], v[24:27], v[48:63]
    s_add_u32 m0, s15, 0x10000
    s_add_u32 s78, s12, 0x80000
    buffer_load_dwordx4 v8, s[64:67], s78 offen lds
    v_exp_f32 v34, v34
    v_exp_f32 v35, v35
    v_exp_f32 v36, v36
    v_exp_f32 v37, v37
    v_exp_f32 v38, v38
    v_exp_f32 v39, v39
    v_cvt_pk_bf16_f32 v32, v32, v33
    v_cvt_pk_bf16_f32 v33, v34, v35
    v_cvt_pk_bf16_f32 v34, v36, v37
    v_cvt_pk_bf16_f32 v35, v38, v39
    s_waitcnt lgkmcnt(0)
    v_mfma_f32_32x32x16_bf16 v[16:31], v[80:83], v[92:95], 0
    s_add_u32 m0, s15, 0x10400
    s_add_u32 s78, s12, 0x82000
    buffer_load_dwordx4 v8, s[64:67], s78 offen lds
    v_exp_f32 v40, v40
    v_exp_f32 v41, v41
    v_exp_f32 v42, v42
    v_exp_f32 v43, v43
    v_mfma_f32_32x32x16_bf16 v[64:79], v[84:87], v[32:35], v[64:79]
    s_setprio 2
    s_mov_b64 exec, s[28:29]
    ds_read_b128 v[84:87], v13 offset:0
    s_mov_b64 exec, -1
    v_exp_f32 v44, v44
    v_exp_f32 v45, v45
    v_exp_f32 v46, v46
    v_exp_f32 v47, v47
    v_cvt_pk_bf16_f32 v40, v40, v41
    v_cvt_pk_bf16_f32 v41, v42, v43
    v_cvt_pk_bf16_f32 v42, v44, v45
    v_cvt_pk_bf16_f32 v43, v46, v47
    v_exp_f32 v16, v16
    v_exp_f32 v17, v17
    v_mfma_f32_32x32x16_bf16 v[64:79], v[88:91], v[40:43], v[64:79]
    s_mov_b64 exec, s[28:29]
    ds_read_b128 v[88:91], v13 offset:512
    s_mov_b64 exec, -1
    s_add_u32 m0, s15, 0x14000
    s_add_u32 s78, s12, 0xa0000
    buffer_load_dwordx4 v8, s[64:67], s78 offen lds
    v_exp_f32 v18, v18
    v_exp_f32 v19, v19
    v_exp_f32 v20, v20
    v_exp_f32 v21, v21
    v_exp_f32 v22, v22
    v_exp_f32 v23, v23
    v_cvt_pk_bf16_f32 v16, v16, v17
    v_cvt_pk_bf16_f32 v17, v18, v19
    v_cvt_pk_bf16_f32 v18, v20, v21
    v_cvt_pk_bf16_f32 v19, v22, v23
    v_mfma_f32_32x32x16_bf16 v[32:47], v[80:83], v[96:99], 0
    s_add_u32 m0, s15, 0x14400
    s_add_u32 s78, s12, 0xa2000
    buffer_load_dwordx4 v8, s[64:67], s78 offen lds
    v_exp_f32 v24, v24
    v_exp_f32 v25, v25
    v_exp_f32 v26, v26
    v_exp_f32 v27, v27
    s_waitcnt lgkmcnt(0)
    v_mfma_f32_32x32x16_bf16 v[48:63], v[84:87], v[16:19], v[48:63]
    s_setprio 1
    ds_read_b128 v[80:83], v11 offset:9216
    v_exp_f32 v28, v28
    v_exp_f32 v29, v29
    v_exp_f32 v30, v30
    v_exp_f32 v31, v31
    v_cvt_pk_bf16_f32 v24, v24, v25
    v_cvt_pk_bf16_f32 v25, v26, v27
    v_cvt_pk_bf16_f32 v26, v28, v29
    v_cvt_pk_bf16_f32 v27, v30, v31
    v_exp_f32 v32, v32
    v_exp_f32 v33, v33
    v_mfma_f32_32x32x16_bf16 v[48:63], v[88:91], v[24:27], v[48:63]
    s_add_u32 m0, s15, 0x18000
    s_add_u32 s78, s12, 0xc0000
    buffer_load_dwordx4 v8, s[64:67], s78 offen lds
    v_exp_f32 v34, v34
    v_exp_f32 v35, v35
    v_exp_f32 v36, v36
    v_exp_f32 v37, v37
    v_exp_f32 v38, v38
    v_exp_f32 v39, v39
    v_cvt_pk_bf16_f32 v32, v32, v33
    v_cvt_pk_bf16_f32 v33, v34, v35
    v_cvt_pk_bf16_f32 v34, v36, v37
    v_cvt_pk_bf16_f32 v35, v38, v39
    s_waitcnt lgkmcnt(0)
    v_mfma_f32_32x32x16_bf16 v[16:31], v[80:83], v[92:95], 0
    s_add_u32 m0, s15, 0x18400
    s_add_u32 s78, s12, 0xc2000
    buffer_load_dwordx4 v8, s[64:67], s78 offen lds
    v_exp_f32 v40, v40
    v_exp_f32 v41, v41
    v_exp_f32 v42, v42
    v_exp_f32 v43, v43
    v_mfma_f32_32x32x16_bf16 v[64:79], v[84:87], v[32:35], v[64:79]
    s_setprio 0
    s_mov_b64 exec, s[28:29]
    ds_read_b128 v[84:87], v13 offset:1024
    s_mov_b64 exec, -1
    v_exp_f32 v44, v44
    v_exp_f32 v45, v45
    v_exp_f32 v46, v46
    v_exp_f32 v47, v47
    v_cvt_pk_bf16_f32 v40, v40, v41
    v_cvt_pk_bf16_f32 v41, v42, v43
    v_cvt_pk_bf16_f32 v42, v44, v45
    v_cvt_pk_bf16_f32 v43, v46, v47
    v_exp_f32 v16, v16
    v_exp_f32 v17, v17
    v_mfma_f32_32x32x16_bf16 v[64:79], v[88:91], v[40:43], v[64:79]
    s_mov_b64 exec, s[28:29]
    ds_read_b128 v[88:91], v13 offset:1536
    s_mov_b64 exec, -1
    s_add_u32 m0, s15, 0x1c000
    s_add_u32 s78, s12, 0xe0000
    buffer_load_dwordx4 v8, s[64:67], s78 offen lds
    v_exp_f32 v18, v18
    v_exp_f32 v19, v19
    v_exp_f32 v20, v20
    v_exp_f32 v21, v21
    v_exp_f32 v22, v22
    v_exp_f32 v23, v23
    v_cvt_pk_bf16_f32 v16, v16, v17
    v_cvt_pk_bf16_f32 v17, v18, v19
    v_cvt_pk_bf16_f32 v18, v20, v21
    v_cvt_pk_bf16_f32 v19, v22, v23
    v_mfma_f32_32x32x16_bf16 v[32:47], v[80:83], v[96:99], 0
    s_add_u32 m0, s15, 0x1c400
    s_add_u32 s78, s12, 0xe2000
    buffer_load_dwordx4 v8, s[64:67], s78 offen lds
    v_exp_f32 v24, v24
    v_exp_f32 v25, v25
    v_exp_f32 v26, v26
    v_exp_f32 v27, v27
    s_waitcnt lgkmcnt(0)
    v_mfma_f32_32x32x16_bf16 v[48:63], v[84:87], v[16:19], v[48:63]
    s_waitcnt vmcnt(9)
    s_barrier
    s_setprio 3
    ds_read_b128 v[80:83], v11 offset:0
    s_add_u32 m0, s92, 0x2000
    s_add_u32 s78, s91, 22528
    buffer_load_dwordx4 v3, s[52:55], s78 offen sc1 lds
    v_exp_f32 v28, v28
    v_exp_f32 v29, v29
    v_exp_f32 v30, v30
    v_exp_f32 v31, v31
    v_cvt_pk_bf16_f32 v24, v24, v25
    v_cvt_pk_bf16_f32 v25, v26, v27
    v_cvt_pk_bf16_f32 v26, v28, v29
    v_cvt_pk_bf16_f32 v27, v30, v31
    v_exp_f32 v32, v32
    v_exp_f32 v33, v33
    v_mfma_f32_32x32x16_bf16 v[48:63], v[88:91], v[24:27], v[48:63]
    v_exp_f32 v34, v34
    v_exp_f32 v35, v35
    v_exp_f32 v36, v36
    v_exp_f32 v37, v37
    v_exp_f32 v38, v38
    v_exp_f32 v39, v39
    v_cvt_pk_bf16_f32 v32, v32, v33
    v_cvt_pk_bf16_f32 v33, v34, v35
    v_cvt_pk_bf16_f32 v34, v36, v37
    v_cvt_pk_bf16_f32 v35, v38, v39
    s_waitcnt lgkmcnt(0)
    v_mfma_f32_32x32x16_bf16 v[16:31], v[80:83], v[92:95], 0
    v_exp_f32 v40, v40
    v_exp_f32 v41, v41
    v_exp_f32 v42, v42
    v_exp_f32 v43, v43
    v_mfma_f32_32x32x16_bf16 v[64:79], v[84:87], v[32:35], v[64:79]
    s_setprio 2
    s_mov_b64 exec, s[28:29]
    ds_read_b128 v[84:87], v12 offset:0
    s_mov_b64 exec, -1
    v_exp_f32 v44, v44
    v_exp_f32 v45, v45
    v_exp_f32 v46, v46
    v_exp_f32 v47, v47
    v_cvt_pk_bf16_f32 v40, v40, v41
    v_cvt_pk_bf16_f32 v41, v42, v43
    v_cvt_pk_bf16_f32 v42, v44, v45
    v_cvt_pk_bf16_f32 v43, v46, v47
    v_exp_f32 v16, v16
    v_exp_f32 v17, v17
    v_mfma_f32_32x32x16_bf16 v[64:79], v[88:91], v[40:43], v[64:79]
    s_mov_b64 exec, s[28:29]
    ds_read_b128 v[88:91], v12 offset:512
    s_mov_b64 exec, -1
    v_exp_f32 v18, v18
    v_exp_f32 v19, v19
    v_exp_f32 v20, v20
    v_exp_f32 v21, v21
    v_exp_f32 v22, v22
    v_exp_f32 v23, v23
    v_cvt_pk_bf16_f32 v16, v16, v17
    v_cvt_pk_bf16_f32 v17, v18, v19
    v_cvt_pk_bf16_f32 v18, v20, v21
    v_cvt_pk_bf16_f32 v19, v22, v23
    v_mfma_f32_32x32x16_bf16 v[32:47], v[80:83], v[96:99], 0
    v_exp_f32 v24, v24
    v_exp_f32 v25, v25
    v_exp_f32 v26, v26
    v_exp_f32 v27, v27
    s_waitcnt lgkmcnt(0)
    v_mfma_f32_32x32x16_bf16 v[48:63], v[84:87], v[16:19], v[48:63]
    s_setprio 1
    ds_read_b128 v[80:83], v11 offset:1024
    v_exp_f32 v28, v28
    v_exp_f32 v29, v29
    v_exp_f32 v30, v30
    v_exp_f32 v31, v31
    v_cvt_pk_bf16_f32 v24, v24, v25
    v_cvt_pk_bf16_f32 v25, v26, v27
    v_cvt_pk_bf16_f32 v26, v28, v29
    v_cvt_pk_bf16_f32 v27, v30, v31
    v_exp_f32 v32, v32
    v_exp_f32 v33, v33
    v_mfma_f32_32x32x16_bf16 v[48:63], v[88:91], v[24:27], v[48:63]
    v_exp_f32 v34, v34
    v_exp_f32 v35, v35
    v_exp_f32 v36, v36
    v_exp_f32 v37, v37
    v_exp_f32 v38, v38
    v_exp_f32 v39, v39
    v_cvt_pk_bf16_f32 v32, v32, v33
    v_cvt_pk_bf16_f32 v33, v34, v35
    v_cvt_pk_bf16_f32 v34, v36, v37
    v_cvt_pk_bf16_f32 v35, v38, v39
    s_waitcnt lgkmcnt(0)
    v_mfma_f32_32x32x16_bf16 v[16:31], v[80:83], v[92:95], 0
    v_exp_f32 v40, v40
    v_exp_f32 v41, v41
    v_exp_f32 v42, v42
    v_exp_f32 v43, v43
    v_mfma_f32_32x32x16_bf16 v[64:79], v[84:87], v[32:35], v[64:79]
    s_setprio 0
    s_mov_b64 exec, s[28:29]
    ds_read_b128 v[84:87], v12 offset:1024
    s_mov_b64 exec, -1
    buffer_load_dword v100, v174, s[52:55], s8 offen sc1
    v_exp_f32 v44, v44
    v_exp_f32 v45, v45
    v_exp_f32 v46, v46
    v_exp_f32 v47, v47
    v_cvt_pk_bf16_f32 v40, v40, v41
    v_cvt_pk_bf16_f32 v41, v42, v43
    v_cvt_pk_bf16_f32 v42, v44, v45
    v_cvt_pk_bf16_f32 v43, v46, v47
    v_exp_f32 v16, v16
    v_exp_f32 v17, v17
    v_mfma_f32_32x32x16_bf16 v[64:79], v[88:91], v[40:43], v[64:79]
    s_mov_b64 exec, s[28:29]
    ds_read_b128 v[88:91], v12 offset:1536
    s_mov_b64 exec, -1
    s_waitcnt vmcnt(0)
    v_xor_b32 v6, s93, v100
    v_cmp_ne_u32 vcc, 0, v6
    s_cbranch_vccz LR4
    s_mov_b32 s90, 0
LS4_l:
    s_sleep 4
    buffer_load_dword v100, v174, s[52:55], s8 offen sc1
    s_waitcnt vmcnt(0)
    v_xor_b32 v6, s93, v100
    v_cmp_ne_u32 vcc, 0, v6
    s_add_u32 s90, s90, 1
    s_cmp_ge_u32 s90, 0x400000
    s_cbranch_scc1 LR4
    s_cbranch_vccnz LS4_l
LR4:
    v_exp_f32 v18, v18
    v_exp_f32 v19, v19
    v_exp_f32 v20, v20
    v_exp_f32 v21, v21
    s_add_u32 s78, s13, 0
    buffer_load_dwordx4 v[144:147], v3, s[52:55], s78 offen sc1
    v_exp_f32 v22, v22
    v_exp_f32 v23, v23
    v_cvt_pk_bf16_f32 v16, v16, v17
    v_cvt_pk_bf16_f32 v17, v18, v19
    v_cvt_pk_bf16_f32 v18, v20, v21
    v_cvt_pk_bf16_f32 v19, v22, v23
    v_mfma_f32_32x32x16_bf16 v[32:47], v[80:83], v[96:99], 0
    s_add_u32 s78, s13, 4096
    buffer_load_dwordx4 v[148:151], v3, s[52:55], s78 offen sc1
    v_exp_f32 v24, v24
    v_exp_f32 v25, v25
    v_exp_f32 v26, v26
    v_exp_f32 v27, v27
    s_waitcnt lgkmcnt(0)
    v_mfma_f32_32x32x16_bf16 v[48:63], v[84:87], v[16:19], v[48:63]
    s_barrier
    s_setprio 3
    ds_read_b128 v[80:83], v11 offset:8192
    s_mov_b32 m0, s92
    s_add_u32 s78, s91, 24576
    buffer_load_dwordx4 v3, s[52:55], s78 offen sc1 lds
    v_exp_f32 v28, v28
    v_exp_f32 v29, v29
    s_add_u32 s78, s13, 8192
    buffer_load_dwordx4 v[152:155], v3, s[52:55], s78 offen sc1
    v_exp_f32 v30, v30
    v_exp_f32 v31, v31
    v_cvt_pk_bf16_f32 v24, v24, v25
    v_cvt_pk_bf16_f32 v25, v26, v27
    v_cvt_pk_bf16_f32 v26, v28, v29
    v_cvt_pk_bf16_f32 v27, v30, v31
    v_exp_f32 v32, v32
    v_exp_f32 v33, v33
    v_mfma_f32_32x32x16_bf16 v[48:63], v[88:91], v[24:27], v[48:63]
    s_add_u32 s78, s13, 12288
    buffer_load_dwordx4 v[156:159], v3, s[52:55], s78 offen sc1
    v_exp_f32 v34, v34
    v_exp_f32 v35, v35
    v_exp_f32 v36, v36
    v_exp_f32 v37, v37
    s_add_u32 s78, s13, 16384
    buffer_load_dwordx4 v[160:163], v3, s[52:55], s78 offen sc1
    v_exp_f32 v38, v38
    v_exp_f32 v39, v39
    v_cvt_pk_bf16_f32 v32, v32, v33
    v_cvt_pk_bf16_f32 v33, v34, v35
    v_cvt_pk_bf16_f32 v34, v36, v37
    v_cvt_pk_bf16_f32 v35, v38, v39
    s_waitcnt lgkmcnt(0)
    v_mfma_f32_32x32x16_bf16 v[16:31], v[80:83], v[92:95], 0
    s_add_u32 s78, s13, 20480
    buffer_load_dwordx4 v[164:167], v3, s[52:55], s78 offen sc1
    v_exp_f32 v40, v40
    v_exp_f32 v41, v41
    v_exp_f32 v42, v42
    v_exp_f32 v43, v43
    v_mfma_f32_32x32x16_bf16 v[64:79], v[84:87], v[32:35], v[64:79]
    s_setprio 2
    s_mov_b64 exec, s[28:29]
    ds_read_b128 v[84:87], v13 offset:0
    s_mov_b64 exec, -1
    v_exp_f32 v44, v44
    v_exp_f32 v45, v45
    v_exp_f32 v46, v46
    v_exp_f32 v47, v47
    ds_read_b64_tr_b16 v[136:137], v170 offset:0
    ds_read_b64_tr_b16 v[138:139], v170 offset:1024
    ds_read_b64_tr_b16 v[140:141], v172 offset:0
    ds_read_b64_tr_b16 v[142:143], v172 offset:1024
    v_cvt_pk_bf16_f32 v40, v40, v41
    v_cvt_pk_bf16_f32 v41, v42, v43
    v_cvt_pk_bf16_f32 v42, v44, v45
    v_cvt_pk_bf16_f32 v43, v46, v47
    v_exp_f32 v16, v16
    v_exp_f32 v17, v17
    v_mfma_f32_32x32x16_bf16 v[64:79], v[88:91], v[40:43], v[64:79]
    s_mov_b64 exec, s[28:29]
    ds_read_b128 v[88:91], v13 offset:512
    s_mov_b64 exec, -1
    v_exp_f32 v18, v18
    v_exp_f32 v19, v19
    v_exp_f32 v20, v20
    v_exp_f32 v21, v21
    s_waitcnt vmcnt(6) lgkmcnt(1)
    v_mfma_f32_32x32x16_bf16 v[104:119], v[136:139], v[144:147], 0
    ds_read_b64_tr_b16 v[136:137], v170 offset:8192
    ds_read_b64_tr_b16 v[138:139], v170 offset:9216
    v_exp_f32 v22, v22
    v_exp_f32 v23, v23
    v_cvt_pk_bf16_f32 v16, v16, v17
    v_cvt_pk_bf16_f32 v17, v18, v19
    v_cvt_pk_bf16_f32 v18, v20, v21
    v_cvt_pk_bf16_f32 v19, v22, v23
    v_mfma_f32_32x32x16_bf16 v[32:47], v[80:83], v[96:99], 0
    v_exp_f32 v24, v24
    v_exp_f32 v25, v25
    v_exp_f32 v26, v26
    v_exp_f32 v27, v27
    v_mfma_f32_32x32x16_bf16 v[48:63], v[84:87], v[16:19], v[48:63]
    s_setprio 1
    ds_read_b128 v[80:83], v11 offset:9216
    v_exp_f32 v28, v28
    v_exp_f32 v29, v29
    v_exp_f32 v30, v30
    v_exp_f32 v31, v31
    v_mfma_f32_32x32x16_bf16 v[120:135], v[140:143], v[144:147], 0
    ds_read_b64_tr_b16 v[140:141], v172 offset:8192
    ds_read_b64_tr_b16 v[142:143], v172 offset:9216
    v_cvt_pk_bf16_f32 v24, v24, v25
    v_cvt_pk_bf16_f32 v25, v26, v27
    v_cvt_pk_bf16_f32 v26, v28, v29
    v_cvt_pk_bf16_f32 v27, v30, v31
    v_exp_f32 v32, v32
    v_exp_f32 v33, v33
    s_waitcnt lgkmcnt(2)
    v_mfma_f32_32x32x16_bf16 v[48:63], v[88:91], v[24:27], v[48:63]
    s_add_u32 s78, s13, 24576
    buffer_load_dwordx4 v[144:147], v3, s[52:55], s78 offen sc1
    v_exp_f32 v34, v34
    v_exp_f32 v35, v35
    v_exp_f32 v36, v36
    v_exp_f32 v37, v37
    s_waitcnt vmcnt(6)
    v_mfma_f32_32x32x16_bf16 v[104:119], v[136:139], v[148:151], v[104:119]
    ds_read_b64_tr_b16 v[136:137], v170 offset:16384
    ds_read_b64_tr_b16 v[138:139], v170 offset:17408
    v_exp_f32 v38, v38
    v_exp_f32 v39, v39
    v_cvt_pk_bf16_f32 v32, v32, v33
    v_cvt_pk_bf16_f32 v33, v34, v35
    v_cvt_pk_bf16_f32 v34, v36, v37
    v_cvt_pk_bf16_f32 v35, v38, v39
    v_mfma_f32_32x32x16_bf16 v[16:31], v[80:83], v[92:95], 0
    v_exp_f32 v40, v40
    v_exp_f32 v41, v41
    v_exp_f32 v42, v42
    v_exp_f32 v43, v43
    v_mfma_f32_32x32x16_bf16 v[64:79], v[84:87], v[32:35], v[64:79]
    s_setprio 0
    s_mov_b64 exec, s[28:29]
    ds_read_b128 v[84:87], v13 offset:1024
    s_mov_b64 exec, -1
    v_exp_f32 v44, v44
    v_exp_f32 v45, v45
    v_exp_f32 v46, v46
    v_exp_f32 v47, v47
    s_waitcnt lgkmcnt(1)
    v_mfma_f32_32x32x16_bf16 v[120:135], v[140:143], v[148:151], v[120:135]
    ds_read_b64_tr_b16 v[140:141], v172 offset:16384
    ds_read_b64_tr_b16 v[142:143], v172 offset:17408
    v_cvt_pk_bf16_f32 v40, v40, v41
    v_cvt_pk_bf16_f32 v41, v42, v43
    v_cvt_pk_bf16_f32 v42, v44, v45
    v_cvt_pk_bf16_f32 v43, v46, v47
    v_exp_f32 v16, v16
    v_exp_f32 v17, v17
    v_mfma_f32_32x32x16_bf16 v[64:79], v[88:91], v[40:43], v[64:79]
    s_mov_b64 exec, s[28:29]
    ds_read_b128 v[88:91], v13 offset:1536
    s_mov_b64 exec, -1
    s_add_u32 s78, s13, 28672
    buffer_load_dwordx4 v[148:151], v3, s[52:55], s78 offen sc1
    v_exp_f32 v18, v18
    v_exp_f32 v19, v19
    v_exp_f32 v20, v20
    v_exp_f32 v21, v21
    s_waitcnt vmcnt(5)
    v_mfma_f32_32x32x16_bf16 v[104:119], v[136:139], v[152:155], v[104:119]
    ds_read_b64_tr_b16 v[136:137], v170 offset:24576
    ds_read_b64_tr_b16 v[138:139], v170 offset:25600
    v_exp_f32 v22, v22
    v_exp_f32 v23, v23
    v_cvt_pk_bf16_f32 v16, v16, v17
    v_cvt_pk_bf16_f32 v17, v18, v19
    v_cvt_pk_bf16_f32 v18, v20, v21
    v_cvt_pk_bf16_f32 v19, v22, v23
    v_mfma_f32_32x32x16_bf16 v[32:47], v[80:83], v[96:99], 0
    v_exp_f32 v24, v24
    v_exp_f32 v25, v25
    v_exp_f32 v26, v26
    v_exp_f32 v27, v27
    s_waitcnt lgkmcnt(0)
    v_mfma_f32_32x32x16_bf16 v[48:63], v[84:87], v[16:19], v[48:63]
    s_barrier
    s_setprio 3
    ds_read_b128 v[80:83], v11 offset:0
    s_add_u32 m0, s92, 0x2000
    s_add_u32 s78, s91, 26624
    buffer_load_dwordx4 v3, s[52:55], s78 offen sc1 lds
    v_exp_f32 v28, v28
    v_exp_f32 v29, v29
    v_exp_f32 v30, v30
    v_exp_f32 v31, v31
    v_mfma_f32_32x32x16_bf16 v[120:135], v[140:143], v[152:155], v[120:135]
    ds_read_b64_tr_b16 v[140:141], v172 offset:24576
    ds_read_b64_tr_b16 v[142:143], v172 offset:25600
    v_cvt_pk_bf16_f32 v24, v24, v25
    v_cvt_pk_bf16_f32 v25, v26, v27
    v_cvt_pk_bf16_f32 v26, v28, v29
    v_cvt_pk_bf16_f32 v27, v30, v31
    v_exp_f32 v32, v32
    v_exp_f32 v33, v33
    v_mfma_f32_32x32x16_bf16 v[48:63], v[88:91], v[24:27], v[48:63]
    s_add_u32 s78, s13, 32768
    buffer_load_dwordx4 v[152:155], v3, s[52:55], s78 offen sc1
    v_exp_f32 v34, v34
    v_exp_f32 v35, v35
    v_exp_f32 v36, v36
    v_exp_f32 v37, v37
    s_waitcnt vmcnt(6)
    v_mfma_f32_32x32x16_bf16 v[104:119], v[136:139], v[156:159], v[104:119]
    ds_read_b64_tr_b16 v[136:137], v170 offset:32768
    ds_read_b64_tr_b16 v[138:139], v170 offset:33792
    v_exp_f32 v38, v38
    v_exp_f32 v39, v39
    v_cvt_pk_bf16_f32 v32, v32, v33
    v_cvt_pk_bf16_f32 v33, v34, v35
    v_cvt_pk_bf16_f32 v34, v36, v37
    v_cvt_pk_bf16_f32 v35, v38, v39
    s_waitcnt lgkmcnt(2)
    v_mfma_f32_32x32x16_bf16 v[16:31], v[80:83], v[92:95], 0
    s_mov_b32 m0, s15
    s_add_u32 s78, s12, 0x100000
    buffer_load_dwordx4 v8, s[64:67], s78 offen lds
    v_exp_f32 v40, v40
    v_exp_f32 v41, v41
    v_exp_f32 v42, v42
    v_exp_f32 v43, v43
    v_mfma_f32_32x32x16_bf16 v[64:79], v[84:87], v[32:35], v[64:79]
    s_setprio 2
    s_mov_b64 exec, s[28:29]
    ds_read_b128 v[84:87], v12 offset:0
    s_mov_b64 exec, -1
    v_exp_f32 v44, v44
    v_exp_f32 v45, v45
    v_exp_f32 v46, v46
    v_exp_f32 v47, v47
    v_mfma_f32_32x32x16_bf16 v[120:135], v[140:143], v[156:159], v[120:135]
    ds_read_b64_tr_b16 v[140:141], v172 offset:32768
    ds_read_b64_tr_b16 v[142:143], v172 offset:33792
    v_cvt_pk_bf16_f32 v40, v40, v41
    v_cvt_pk_bf16_f32 v41, v42, v43
    v_cvt_pk_bf16_f32 v42, v44, v45
    v_cvt_pk_bf16_f32 v43, v46, v47
    v_exp_f32 v16, v16
    v_exp_f32 v17, v17
    v_mfma_f32_32x32x16_bf16 v[64:79], v[88:91], v[40:43], v[64:79]
    s_mov_b64 exec, s[28:29]
    ds_read_b128 v[88:91], v12 offset:512
    s_mov_b64 exec, -1
    s_add_u32 s78, s13, 36864
    buffer_load_dwordx4 v[156:159], v3, s[52:55], s78 offen sc1
    v_exp_f32 v18, v18
    v_exp_f32 v19, v19
    v_exp_f32 v20, v20
    v_exp_f32 v21, v21
    s_waitcnt vmcnt(7) lgkmcnt(1)
    v_mfma_f32_32x32x16_bf16 v[104:119], v[136:139], v[160:163], v[104:119]
    ds_read_b64_tr_b16 v[136:137], v170 offset:40960
    ds_read_b64_tr_b16 v[138:139], v170 offset:41984
    v_exp_f32 v22, v22
    v_exp_f32 v23, v23
    v_cvt_pk_bf16_f32 v16, v16, v17
    v_cvt_pk_bf16_f32 v17, v18, v19
    v_cvt_pk_bf16_f32 v18, v20, v21
    v_cvt_pk_bf16_f32 v19, v22, v23
    v_mfma_f32_32x32x16_bf16 v[32:47], v[80:83], v[96:99], 0
    s_add_u32 m0, s15, 0x400
    s_add_u32 s78, s12, 0x102000
    buffer_load_dwordx4 v8, s[64:67], s78 offen lds
    v_exp_f32 v24, v24
    v_exp_f32 v25, v25
    v_exp_f32 v26, v26
    v_exp_f32 v27, v27
    v_mfma_f32_32x32x16_bf16 v[48:63], v[84:87], v[16:19], v[48:63]
    s_setprio 1
    ds_read_b128 v[80:83], v11 offset:1024
    v_exp_f32 v28, v28
    v_exp_f32 v29, v29
    v_exp_f32 v30, v30
    v_exp_f32 v31, v31
    v_mfma_f32_32x32x16_bf16 v[120:135], v[140:143], v[160:163], v[120:135]
    ds_read_b64_tr_b16 v[140:141], v172 offset:40960
    ds_read_b64_tr_b16 v[142:143], v172 offset:41984
    v_cvt_pk_bf16_f32 v24, v24, v25
    v_cvt_pk_bf16_f32 v25, v26, v27
    v_cvt_pk_bf16_f32 v26, v28, v29
    v_cvt_pk_bf16_f32 v27, v30, v31
    v_exp_f32 v32, v32
    v_exp_f32 v33, v33
    s_waitcnt lgkmcnt(2)
    v_mfma_f32_32x32x16_bf16 v[48:63], v[88:91], v[24:27], v[48:63]
    s_add_u32 s78, s13, 40960
    buffer_load_dwordx4 v[160:163], v3, s[52:55], s78 offen sc1
    v_exp_f32 v34, v34
    v_exp_f32 v35, v35
    v_exp_f32 v36, v36
    v_exp_f32 v37, v37
    s_waitcnt vmcnt(8)
    v_mfma_f32_32x32x16_bf16 v[104:119], v[136:139], v[164:167], v[104:119]
    ds_read_b64_tr_b16 v[136:137], v170 offset:49152
    ds_read_b64_tr_b16 v[138:139], v170 offset:50176
    v_exp_f32 v38, v38
    v_exp_f32 v39, v39
    v_cvt_pk_bf16_f32 v32, v32, v33
    v_cvt_pk_bf16_f32 v33, v34, v35
    v_cvt_pk_bf16_f32 v34, v36, v37
    v_cvt_pk_bf16_f32 v35, v38, v39
    v_mfma_f32_32x32x16_bf16 v[16:31], v[80:83], v[92:95], 0
    v_exp_f32 v40, v40
    v_exp_f32 v41, v41
    v_exp_f32 v42, v42
    v_exp_f32 v43, v43
    v_mfma_f32_32x32x16_bf16 v[64:79], v[84:87], v[32:35], v[64:79]
    s_setprio 0
    s_mov_b64 exec, s[28:29]
    ds_read_b128 v[84:87], v12 offset:1024
    s_mov_b64 exec, -1
    v_exp_f32 v44, v44
    v_exp_f32 v45, v45
    v_exp_f32 v46, v46
    v_exp_f32 v47, v47
    s_waitcnt lgkmcnt(1)
    v_mfma_f32_32x32x16_bf16 v[120:135], v[140:143], v[164:167], v[120:135]
    ds_read_b64_tr_b16 v[140:141], v172 offset:49152
    ds_read_b64_tr_b16 v[142:143], v172 offset:50176
    v_cvt_pk_bf16_f32 v40, v40, v41
    v_cvt_pk_bf16_f32 v41, v42, v43
    v_cvt_pk_bf16_f32 v42, v44, v45
    v_cvt_pk_bf16_f32 v43, v46, v47
    v_exp_f32 v16, v16
    v_exp_f32 v17, v17
    v_mfma_f32_32x32x16_bf16 v[64:79], v[88:91], v[40:43], v[64:79]
    s_mov_b64 exec, s[28:29]
    ds_read_b128 v[88:91], v12 offset:1536
    s_mov_b64 exec, -1
    s_add_u32 s78, s13, 45056
    buffer_load_dwordx4 v[164:167], v3, s[52:55], s78 offen sc1
    v_exp_f32 v18, v18
    v_exp_f32 v19, v19
    v_exp_f32 v20, v20
    v_exp_f32 v21, v21
    s_waitcnt vmcnt(8)
    v_mfma_f32_32x32x16_bf16 v[104:119], v[136:139], v[144:147], v[104:119]
    ds_read_b64_tr_b16 v[136:137], v170 offset:57344
    ds_read_b64_tr_b16 v[138:139], v170 offset:58368
    v_exp_f32 v22, v22
    v_exp_f32 v23, v23
    v_cvt_pk_bf16_f32 v16, v16, v17
    v_cvt_pk_bf16_f32 v17, v18, v19
    v_cvt_pk_bf16_f32 v18, v20, v21
    v_cvt_pk_bf16_f32 v19, v22, v23
    v_mfma_f32_32x32x16_bf16 v[32:47], v[80:83], v[96:99], 0
    v_exp_f32 v24, v24
    v_exp_f32 v25, v25
    v_exp_f32 v26, v26
    v_exp_f32 v27, v27
    s_waitcnt lgkmcnt(0)
    v_mfma_f32_32x32x16_bf16 v[48:63], v[84:87], v[16:19], v[48:63]
    s_waitcnt vmcnt(6)
    s_barrier
    s_setprio 3
    ds_read_b128 v[80:83], v11 offset:8192
    s_mov_b32 m0, s92
    s_add_u32 s78, s91, 28672
    buffer_load_dwordx4 v3, s[52:55], s78 offen sc1 lds
    v_exp_f32 v28, v28
    v_exp_f32 v29, v29
    v_exp_f32 v30, v30
    v_exp_f32 v31, v31
    v_mfma_f32_32x32x16_bf16 v[120:135], v[140:143], v[144:147], v[120:135]
    ds_read_b64_tr_b16 v[140:141], v172 offset:57344
    ds_read_b64_tr_b16 v[142:143], v172 offset:58368
    v_cvt_pk_bf16_f32 v24, v24, v25
    v_cvt_pk_bf16_f32 v25, v26, v27
    v_cvt_pk_bf16_f32 v26, v28, v29
    v_cvt_pk_bf16_f32 v27, v30, v31
    v_exp_f32 v32, v32
    v_exp_f32 v33, v33
    v_mfma_f32_32x32x16_bf16 v[48:63], v[88:91], v[24:27], v[48:63]
    s_add_u32 s78, s13, 49152
    buffer_load_dwordx4 v[144:147], v3, s[52:55], s78 offen sc1
    v_exp_f32 v34, v34
    v_exp_f32 v35, v35
    v_exp_f32 v36, v36
    v_exp_f32 v37, v37
    v_mfma_f32_32x32x16_bf16 v[104:119], v[136:139], v[148:151], v[104:119]
    ds_read_b64_tr_b16 v[136:137], v171 offset:0
    ds_read_b64_tr_b16 v[138:139], v171 offset:1024
    v_exp_f32 v38, v38
    v_exp_f32 v39, v39
    v_cvt_pk_bf16_f32 v32, v32, v33
    v_cvt_pk_bf16_f32 v33, v34, v35
    v_cvt_pk_bf16_f32 v34, v36, v37
    v_cvt_pk_bf16_f32 v35, v38, v39
    s_waitcnt lgkmcnt(2)
    v_mfma_f32_32x32x16_bf16 v[16:31], v[80:83], v[92:95], 0
    s_add_u32 m0, s15, 0x4000
    s_add_u32 s78, s12, 0x120000
    buffer_load_dwordx4 v8, s[64:67], s78 offen lds
    v_exp_f32 v40, v40
    v_exp_f32 v41, v41
    v_exp_f32 v42, v42
    v_exp_f32 v43, v43
    v_mfma_f32_32x32x16_bf16 v[64:79], v[84:87], v[32:35], v[64:79]
    s_setprio 2
    s_mov_b64 exec, s[28:29]
    ds_read_b128 v[84:87], v13 offset:0
    s_mov_b64 exec, -1
    v_exp_f32 v44, v44
    v_exp_f32 v45, v45
    v_exp_f32 v46, v46
    v_exp_f32 v47, v47
    v_mfma_f32_32x32x16_bf16 v[120:135], v[140:143], v[148:151], v[120:135]
    ds_read_b64_tr_b16 v[140:141], v173 offset:0
    ds_read_b64_tr_b16 v[142:143], v173 offset:1024
    v_cvt_pk_bf16_f32 v40, v40, v41
    v_cvt_pk_bf16_f32 v41, v42, v43
    v_cvt_pk_bf16_f32 v42, v44, v45
    v_cvt_pk_bf16_f32 v43, v46, v47
    v_exp_f32 v16, v16
    v_exp_f32 v17, v17
    v_mfma_f32_32x32x16_bf16 v[64:79], v[88:91], v[40:43], v[64:79]
    s_mov_b64 exec, s[28:29]
    ds_read_b128 v[88:91], v13 offset:512
    s_mov_b64 exec, -1
    s_add_u32 s78, s13, 53248
    buffer_load_dwordx4 v[148:151], v3, s[52:55], s78 offen sc1
    v_exp_f32 v18, v18
    v_exp_f32 v19, v19
    v_exp_f32 v20, v20
    v_exp_f32 v21, v21
    s_waitcnt vmcnt(9) lgkmcnt(1)
    v_mfma_f32_32x32x16_bf16 v[104:119], v[136:139], v[152:155], v[104:119]
    ds_read_b64_tr_b16 v[136:137], v171 offset:8192
    ds_read_b64_tr_b16 v[138:139], v171 offset:9216
    v_exp_f32 v22, v22
    v_exp_f32 v23, v23
    v_cvt_pk_bf16_f32 v16, v16, v17
    v_cvt_pk_bf16_f32 v17, v18, v19
    v_cvt_pk_bf16_f32 v18, v20, v21
    v_cvt_pk_bf16_f32 v19, v22, v23
    v_mfma_f32_32x32x16_bf16 v[32:47], v[80:83], v[96:99], 0
    s_add_u32 m0, s15, 0x4400
    s_add_u32 s78, s12, 0x122000
    buffer_load_dwordx4 v8, s[64:67], s78 offen lds
    v_exp_f32 v24, v24
    v_exp_f32 v25, v25
    v_exp_f32 v26, v26
    v_exp_f32 v27, v27
    v_mfma_f32_32x32x16_bf16 v[48:63], v[84:87], v[16:19], v[48:63]
    s_setprio 1
    ds_read_b128 v[80:83], v11 offset:9216
    v_exp_f32 v28, v28
    v_exp_f32 v29, v29
    v_exp_f32 v30, v30
    v_exp_f32 v31, v31
    v_mfma_f32_32x32x16_bf16 v[120:135], v[140:143], v[152:155], v[120:135]
    ds_read_b64_tr_b16 v[140:141], v173 offset:8192
    ds_read_b64_tr_b16 v[142:143], v173 offset:9216
    v_cvt_pk_bf16_f32 v24, v24, v25
    v_cvt_pk_bf16_f32 v25, v26, v27
    v_cvt_pk_bf16_f32 v26, v28, v29
    v_cvt_pk_bf16_f32 v27, v30, v31
    v_exp_f32 v32, v32
    v_exp_f32 v33, v33
    s_waitcnt lgkmcnt(2)
    v_mfma_f32_32x32x16_bf16 v[48:63], v[88:91], v[24:27], v[48:63]
    s_add_u32 s78, s13, 57344
    buffer_load_dwordx4 v[152:155], v3, s[52:55], s78 offen sc1
    v_exp_f32 v34, v34
    v_exp_f32 v35, v35
    v_exp_f32 v36, v36
    v_exp_f32 v37, v37
    s_waitcnt vmcnt(9)
    v_mfma_f32_32x32x16_bf16 v[104:119], v[136:139], v[156:159], v[104:119]
    ds_read_b64_tr_b16 v[136:137], v171 offset:16384
    ds_read_b64_tr_b16 v[138:139], v171 offset:17408
    v_exp_f32 v38, v38
    v_exp_f32 v39, v39
    v_cvt_pk_bf16_f32 v32, v32, v33
    v_cvt_pk_bf16_f32 v33, v34, v35
    v_cvt_pk_bf16_f32 v34, v36, v37
    v_cvt_pk_bf16_f32 v35, v38, v39
    v_mfma_f32_32x32x16_bf16 v[16:31], v[80:83], v[92:95], 0
    s_add_u32 m0, s15, 0x8000
    s_add_u32 s78, s12, 0x140000
    buffer_load_dwordx4 v8, s[64:67], s78 offen lds
    v_exp_f32 v40, v40
    v_exp_f32 v41, v41
    v_exp_f32 v42, v42
    v_exp_f32 v43, v43
    v_mfma_f32_32x32x16_bf16 v[64:79], v[84:87], v[32:35], v[64:79]
    s_setprio 0
    s_mov_b64 exec, s[28:29]
    ds_read_b128 v[84:87], v13 offset:1024
    s_mov_b64 exec, -1
    v_exp_f32 v44, v44
    v_exp_f32 v45, v45
    v_exp_f32 v46, v46
    v_exp_f32 v47, v47
    s_waitcnt lgkmcnt(1)
    v_mfma_f32_32x32x16_bf16 v[120:135], v[140:143], v[156:159], v[120:135]
    ds_read_b64_tr_b16 v[140:141], v173 offset:16384
    ds_read_b64_tr_b16 v[142:143], v173 offset:17408
    v_cvt_pk_bf16_f32 v40, v40, v41
    v_cvt_pk_bf16_f32 v41, v42, v43
    v_cvt_pk_bf16_f32 v42, v44, v45
    v_cvt_pk_bf16_f32 v43, v46, v47
    v_exp_f32 v16, v16
    v_exp_f32 v17, v17
    v_mfma_f32_32x32x16_bf16 v[64:79], v[88:91], v[40:43], v[64:79]
    s_mov_b64 exec, s[28:29]
    ds_read_b128 v[88:91], v13 offset:1536
    s_mov_b64 exec, -1
    s_add_u32 s78, s13, 61440
    buffer_load_dwordx4 v[156:159], v3, s[52:55], s78 offen sc1
    v_exp_f32 v18, v18
    v_exp_f32 v19, v19
    v_exp_f32 v20, v20
    v_exp_f32 v21, v21
    s_waitcnt vmcnt(9)
    v_mfma_f32_32x32x16_bf16 v[104:119], v[136:139], v[160:163], v[104:119]
    ds_read_b64_tr_b16 v[136:137], v171 offset:24576
    ds_read_b64_tr_b16 v[138:139], v171 offset:25600
    v_exp_f32 v22, v22
    v_exp_f32 v23, v23
    v_cvt_pk_bf16_f32 v16, v16, v17
    v_cvt_pk_bf16_f32 v17, v18, v19
    v_cvt_pk_bf16_f32 v18, v20, v21
    v_cvt_pk_bf16_f32 v19, v22, v23
    v_mfma_f32_32x32x16_bf16 v[32:47], v[80:83], v[96:99], 0
    s_add_u32 m0, s15, 0x8400
    s_add_u32 s78, s12, 0x142000
    buffer_load_dwordx4 v8, s[64:67], s78 offen lds
    v_exp_f32 v24, v24
    v_exp_f32 v25, v25
    v_exp_f32 v26, v26
    v_exp_f32 v27, v27
    s_waitcnt lgkmcnt(0)
    v_mfma_f32_32x32x16_bf16 v[48:63], v[84:87], v[16:19], v[48:63]
    s_waitcnt vmcnt(8)
    s_waitcnt vmcnt(4)
    s_barrier
    s_setprio 3
    ds_read_b128 v[80:83], v11 offset:0
    s_add_u32 m0, s92, 0x2000
    s_add_u32 s78, s91, 30720
    buffer_load_dwordx4 v3, s[52:55], s78 offen sc1 lds
    v_exp_f32 v28, v28
    v_exp_f32 v29, v29
    v_exp_f32 v30, v30
    v_exp_f32 v31, v31
    v_mfma_f32_32x32x16_bf16 v[120:135], v[140:143], v[160:163], v[120:135]
    ds_read_b64_tr_b16 v[140:141], v173 offset:24576
    ds_read_b64_tr_b16 v[142:143], v173 offset:25600
    v_cvt_pk_bf16_f32 v24, v24, v25
    v_cvt_pk_bf16_f32 v25, v26, v27
    v_cvt_pk_bf16_f32 v26, v28, v29
    v_cvt_pk_bf16_f32 v27, v30, v31
    v_exp_f32 v32, v32
    v_exp_f32 v33, v33
    v_mfma_f32_32x32x16_bf16 v[48:63], v[88:91], v[24:27], v[48:63]
    s_add_u32 s78, s13, 65536
    buffer_load_dwordx4 v[160:163], v3, s[52:55], s78 offen sc1
    v_exp_f32 v34, v34
    v_exp_f32 v35, v35
    v_exp_f32 v36, v36
    v_exp_f32 v37, v37
    v_mfma_f32_32x32x16_bf16 v[104:119], v[136:139], v[164:167], v[104:119]
    ds_read_b64_tr_b16 v[136:137], v171 offset:32768
    ds_read_b64_tr_b16 v[138:139], v171 offset:33792
    v_exp_f32 v38, v38
    v_exp_f32 v39, v39
    v_cvt_pk_bf16_f32 v32, v32, v33
    v_cvt_pk_bf16_f32 v33, v34, v35
    v_cvt_pk_bf16_f32 v34, v36, v37
    v_cvt_pk_bf16_f32 v35, v38, v39
    s_waitcnt lgkmcnt(2)
    v_mfma_f32_32x32x16_bf16 v[16:31], v[80:83], v[92:95], 0
    s_add_u32 m0, s15, 0xc000
    s_add_u32 s78, s12, 0x0
    buffer_load_dwordx4 v8, s[60:63], s78 offen lds
    v_exp_f32 v40, v40
    v_exp_f32 v41, v41
    v_exp_f32 v42, v42
    v_exp_f32 v43, v43
    v_mfma_f32_32x32x16_bf16 v[64:79], v[84:87], v[32:35], v[64:79]
    s_setprio 2
    s_mov_b64 exec, s[28:29]
    ds_read_b128 v[84:87], v12 offset:0
    s_mov_b64 exec, -1
    v_exp_f32 v44, v44
    v_exp_f32 v45, v45
    v_exp_f32 v46, v46
    v_exp_f32 v47, v47
    v_mfma_f32_32x32x16_bf16 v[120:135], v[140:143], v[164:167], v[120:135]
    ds_read_b64_tr_b16 v[140:141], v173 offset:32768
    ds_read_b64_tr_b16 v[142:143], v173 offset:33792
    v_cvt_pk_bf16_f32 v40, v40, v41
    v_cvt_pk_bf16_f32 v41, v42, v43
    v_cvt_pk_bf16_f32 v42, v44, v45
    v_cvt_pk_bf16_f32 v43, v46, v47
    v_exp_f32 v16, v16
    v_exp_f32 v17, v17
    v_mfma_f32_32x32x16_bf16 v[64:79], v[88:91], v[40:43], v[64:79]
    s_mov_b64 exec, s[28:29]
    ds_read_b128 v[88:91], v12 offset:512
    s_mov_b64 exec, -1
    s_add_u32 s78, s13, 69632
    buffer_load_dwordx4 v[164:167], v3, s[52:55], s78 offen sc1
    v_exp_f32 v18, v18
    v_exp_f32 v19, v19
    v_exp_f32 v20, v20
    v_exp_f32 v21, v21
    s_waitcnt lgkmcnt(1)
    v_mfma_f32_32x32x16_bf16 v[104:119], v[136:139], v[144:147], v[104:119]
    ds_read_b64_tr_b16 v[136:137], v171 offset:40960
    ds_read_b64_tr_b16 v[138:139], v171 offset:41984
    v_exp_f32 v22, v22
    v_exp_f32 v23, v23
    v_cvt_pk_bf16_f32 v16, v16, v17
    v_cvt_pk_bf16_f32 v17, v18, v19
    v_cvt_pk_bf16_f32 v18, v20, v21
    v_cvt_pk_bf16_f32 v19, v22, v23
    v_mfma_f32_32x32x16_bf16 v[32:47], v[80:83], v[96:99], 0
    s_add_u32 m0, s15, 0xc400
    s_add_u32 s78, s12, 0x2000
    buffer_load_dwordx4 v8, s[60:63], s78 offen lds
    v_exp_f32 v24, v24
    v_exp_f32 v25, v25
    v_exp_f32 v26, v26
    v_exp_f32 v27, v27
    v_mfma_f32_32x32x16_bf16 v[48:63], v[84:87], v[16:19], v[48:63]
    s_setprio 1
    ds_read_b128 v[80:83], v11 offset:1024
    v_exp_f32 v28, v28
    v_exp_f32 v29, v29
    v_exp_f32 v30, v30
    v_exp_f32 v31, v31
    v_mfma_f32_32x32x16_bf16 v[120:135], v[140:143], v[144:147], v[120:135]
    ds_read_b64_tr_b16 v[140:141], v173 offset:40960
    ds_read_b64_tr_b16 v[142:143], v173 offset:41984
    v_cvt_pk_bf16_f32 v24, v24, v25
    v_cvt_pk_bf16_f32 v25, v26, v27
    v_cvt_pk_bf16_f32 v26, v28, v29
    v_cvt_pk_bf16_f32 v27, v30, v31
    v_exp_f32 v32, v32
    v_exp_f32 v33, v33
    s_waitcnt lgkmcnt(2)
    v_mfma_f32_32x32x16_bf16 v[48:63], v[88:91], v[24:27], v[48:63]
    s_add_u32 s78, s13, 73728
    buffer_load_dwordx4 v[144:147], v3, s[52:55], s78 offen sc1
    v_exp_f32 v34, v34
    v_exp_f32 v35, v35
    v_exp_f32 v36, v36
    v_exp_f32 v37, v37
    v_mfma_f32_32x32x16_bf16 v[104:119], v[136:139], v[148:151], v[104:119]
    ds_read_b64_tr_b16 v[136:137], v171 offset:49152
    ds_read_b64_tr_b16 v[138:139], v171 offset:50176
    v_exp_f32 v38, v38
    v_exp_f32 v39, v39
    v_cvt_pk_bf16_f32 v32, v32, v33
    v_cvt_pk_bf16_f32 v33, v34, v35
    v_cvt_pk_bf16_f32 v34, v36, v37
    v_cvt_pk_bf16_f32 v35, v38, v39
    v_mfma_f32_32x32x16_bf16 v[16:31], v[80:83], v[92:95], 0
    s_add_u32 m0, s15, 0x10000
    s_add_u32 s78, s12, 0x20000
    buffer_load_dwordx4 v8, s[60:63], s78 offen lds
    v_exp_f32 v40, v40
    v_exp_f32 v41, v41
    v_exp_f32 v42, v42
    v_exp_f32 v43, v43
    v_mfma_f32_32x32x16_bf16 v[64:79], v[84:87], v[32:35], v[64:79]
    s_setprio 0
    s_mov_b64 exec, s[28:29]
    ds_read_b128 v[84:87], v12 offset:1024
    s_mov_b64 exec, -1
    v_exp_f32 v44, v44
    v_exp_f32 v45, v45
    v_exp_f32 v46, v46
    v_exp_f32 v47, v47
    s_waitcnt lgkmcnt(1)
    v_mfma_f32_32x32x16_bf16 v[120:135], v[140:143], v[148:151], v[120:135]
    ds_read_b64_tr_b16 v[140:141], v173 offset:49152
    ds_read_b64_tr_b16 v[142:143], v173 offset:50176
    v_cvt_pk_bf16_f32 v40, v40, v41
    v_cvt_pk_bf16_f32 v41, v42, v43
    v_cvt_pk_bf16_f32 v42, v44, v45
    v_cvt_pk_bf16_f32 v43, v46, v47
    v_exp_f32 v16, v16
    v_exp_f32 v17, v17
    v_mfma_f32_32x32x16_bf16 v[64:79], v[88:91], v[40:43], v[64:79]
    s_mov_b64 exec, s[28:29]
    ds_read_b128 v[88:91], v12 offset:1536
    s_mov_b64 exec, -1
    s_add_u32 s78, s13, 77824
    buffer_load_dwordx4 v[148:151], v3, s[52:55], s78 offen sc1
    v_exp_f32 v18, v18
    v_exp_f32 v19, v19
    v_exp_f32 v20, v20
    v_exp_f32 v21, v21
    s_waitcnt vmcnt(11)
    v_mfma_f32_32x32x16_bf16 v[104:119], v[136:139], v[152:155], v[104:119]
    ds_read_b64_tr_b16 v[136:137], v171 offset:57344
    ds_read_b64_tr_b16 v[138:139], v171 offset:58368
    v_exp_f32 v22, v22
    v_exp_f32 v23, v23
    v_cvt_pk_bf16_f32 v16, v16, v17
    v_cvt_pk_bf16_f32 v17, v18, v19
    v_cvt_pk_bf16_f32 v18, v20, v21
    v_cvt_pk_bf16_f32 v19, v22, v23
    v_mfma_f32_32x32x16_bf16 v[32:47], v[80:83], v[96:99], 0
    s_add_u32 m0, s15, 0x10400
    s_add_u32 s78, s12, 0x22000
    buffer_load_dwordx4 v8, s[60:63], s78 offen lds
    v_exp_f32 v24, v24
    v_exp_f32 v25, v25
    v_exp_f32 v26, v26
    v_exp_f32 v27, v27
    s_waitcnt lgkmcnt(0)
    v_mfma_f32_32x32x16_bf16 v[48:63], v[84:87], v[16:19], v[48:63]
    s_waitcnt vmcnt(8)
    s_barrier
    s_setprio 3
    ds_read_b128 v[80:83], v11 offset:8192
    v_exp_f32 v28, v28
    v_exp_f32 v29, v29
    v_exp_f32 v30, v30
    v_exp_f32 v31, v31
    v_mfma_f32_32x32x16_bf16 v[120:135], v[140:143], v[152:155], v[120:135]
    ds_read_b64_tr_b16 v[140:141], v173 offset:57344
    ds_read_b64_tr_b16 v[142:143], v173 offset:58368
    v_cvt_pk_bf16_f32 v24, v24, v25
    v_cvt_pk_bf16_f32 v25, v26, v27
    v_cvt_pk_bf16_f32 v26, v28, v29
    v_cvt_pk_bf16_f32 v27, v30, v31
    v_exp_f32 v32, v32
    v_exp_f32 v33, v33
    v_mfma_f32_32x32x16_bf16 v[48:63], v[88:91], v[24:27], v[48:63]
    s_add_u32 s78, s13, 81920
    buffer_load_dwordx4 v[152:155], v3, s[52:55], s78 offen sc1
    v_exp_f32 v34, v34
    v_exp_f32 v35, v35
    v_exp_f32 v36, v36
    v_exp_f32 v37, v37
    v_mfma_f32_32x32x16_bf16 v[104:119], v[136:139], v[156:159], v[104:119]
    ds_read_b64_tr_b16 v[136:137], v170 offset:0
    ds_read_b64_tr_b16 v[138:139], v170 offset:1024
    v_exp_f32 v38, v38
    v_exp_f32 v39, v39
    v_cvt_pk_bf16_f32 v32, v32, v33
    v_cvt_pk_bf16_f32 v33, v34, v35
    v_cvt_pk_bf16_f32 v34, v36, v37
    v_cvt_pk_bf16_f32 v35, v38, v39
    s_waitcnt lgkmcnt(2)
    v_mfma_f32_32x32x16_bf16 v[16:31], v[80:83], v[92:95], 0
    s_add_u32 m0, s15, 0x14000
    s_add_u32 s78, s12, 0x40000
    buffer_load_dwordx4 v8, s[60:63], s78 offen lds
    v_exp_f32 v40, v40
    v_exp_f32 v41, v41
    v_exp_f32 v42, v42
    v_exp_f32 v43, v43
    v_mfma_f32_32x32x16_bf16 v[64:79], v[84:87], v[32:35], v[64:79]
    s_setprio 2
    s_mov_b64 exec, s[28:29]
    ds_read_b128 v[84:87], v13 offset:0
    s_mov_b64 exec, -1
    v_exp_f32 v44, v44
    v_exp_f32 v45, v45
    v_exp_f32 v46, v46
    v_exp_f32 v47, v47
    v_mfma_f32_32x32x16_bf16 v[120:135], v[140:143], v[156:159], v[120:135]
    ds_read_b64_tr_b16 v[140:141], v172 offset:0
    ds_read_b64_tr_b16 v[142:143], v172 offset:1024
    v_cvt_pk_bf16_f32 v40, v40, v41
    v_cvt_pk_bf16_f32 v41, v42, v43
    v_cvt_pk_bf16_f32 v42, v44, v45
    v_cvt_pk_bf16_f32 v43, v46, v47
    v_exp_f32 v16, v16
    v_exp_f32 v17, v17
    v_mfma_f32_32x32x16_bf16 v[64:79], v[88:91], v[40:43], v[64:79]
    s_mov_b64 exec, s[28:29]
    ds_read_b128 v[88:91], v13 offset:512
    s_mov_b64 exec, -1
    s_add_u32 s78, s13, 86016
    s_cmp_lt_u32 s72, 4
    s_cselect_b32 s78, s78, 0x40000000
    buffer_load_dwordx4 v[156:159], v3, s[52:55], s78 offen sc1
    v_exp_f32 v18, v18
    v_exp_f32 v19, v19
    v_exp_f32 v20, v20
    v_exp_f32 v21, v21
    s_waitcnt vmcnt(10) lgkmcnt(0)
    v_mfma_f32_32x32x16_bf16 v[104:119], v[136:139], v[160:163], v[104:119]
    ds_read_b64_tr_b16 v[136:137], v170 offset:8192
    ds_read_b64_tr_b16 v[138:139], v170 offset:9216
    v_exp_f32 v22, v22
    v_exp_f32 v23, v23
    v_cvt_pk_bf16_f32 v16, v16, v17
    v_cvt_pk_bf16_f32 v17, v18, v19
    v_cvt_pk_bf16_f32 v18, v20, v21
    v_cvt_pk_bf16_f32 v19, v22, v23
    v_mfma_f32_32x32x16_bf16 v[32:47], v[80:83], v[96:99], 0
    s_add_u32 m0, s15, 0x14400
    s_add_u32 s78, s12, 0x42000
    buffer_load_dwordx4 v8, s[60:63], s78 offen lds
    v_exp_f32 v24, v24
    v_exp_f32 v25, v25
    v_exp_f32 v26, v26
    v_exp_f32 v27, v27
    v_mfma_f32_32x32x16_bf16 v[48:63], v[84:87], v[16:19], v[48:63]
    s_setprio 1
    ds_read_b128 v[80:83], v11 offset:9216
    v_exp_f32 v28, v28
    v_exp_f32 v29, v29
    v_exp_f32 v30, v30
    v_exp_f32 v31, v31
    v_mfma_f32_32x32x16_bf16 v[120:135], v[140:143], v[160:163], v[120:135]
    ds_read_b64_tr_b16 v[140:141], v172 offset:8192
    ds_read_b64_tr_b16 v[142:143], v172 offset:9216
    v_cvt_pk_bf16_f32 v24, v24, v25
    v_cvt_pk_bf16_f32 v25, v26, v27
    v_cvt_pk_bf16_f32 v26, v28, v29
    v_cvt_pk_bf16_f32 v27, v30, v31
    v_exp_f32 v32, v32
    v_exp_f32 v33, v33
    v_mfma_f32_32x32x16_bf16 v[48:63], v[88:91], v[24:27], v[48:63]
    s_add_u32 m0, s15, 0x18000
    s_add_u32 s78, s12, 0x60000
    buffer_load_dwordx4 v8, s[60:63], s78 offen lds
    v_exp_f32 v34, v34
    v_exp_f32 v35, v35
    v_exp_f32 v36, v36
    v_exp_f32 v37, v37
    v_exp_f32 v38, v38
    v_exp_f32 v39, v39
    v_cvt_pk_bf16_f32 v32, v32, v33
    v_cvt_pk_bf16_f32 v33, v34, v35
    v_cvt_pk_bf16_f32 v34, v36, v37
    v_cvt_pk_bf16_f32 v35, v38, v39
    s_waitcnt lgkmcnt(0)
    v_mfma_f32_32x32x16_bf16 v[16:31], v[80:83], v[92:95], 0
    s_add_u32 m0, s15, 0x18400
    s_add_u32 s78, s12, 0x62000
    buffer_load_dwordx4 v8, s[60:63], s78 offen lds
    v_exp_f32 v40, v40
    v_exp_f32 v41, v41
    v_exp_f32 v42, v42
    v_exp_f32 v43, v43
    v_mfma_f32_32x32x16_bf16 v[64:79], v[84:87], v[32:35], v[64:79]
    s_setprio 0
    s_mov_b64 exec, s[28:29]
    ds_read_b128 v[84:87], v13 offset:1024
    s_mov_b64 exec, -1
    v_exp_f32 v44, v44
    v_exp_f32 v45, v45
    v_exp_f32 v46, v46
    v_exp_f32 v47, v47
    v_cvt_pk_bf16_f32 v40, v40, v41
    v_cvt_pk_bf16_f32 v41, v42, v43
    v_cvt_pk_bf16_f32 v42, v44, v45
    v_cvt_pk_bf16_f32 v43, v46, v47
    v_exp_f32 v16, v16
    v_exp_f32 v17, v17
    v_mfma_f32_32x32x16_bf16 v[64:79], v[88:91], v[40:43], v[64:79]
    s_mov_b64 exec, s[28:29]
    ds_read_b128 v[88:91], v13 offset:1536
    s_mov_b64 exec, -1
    v_exp_f32 v18, v18
    v_exp_f32 v19, v19
    v_exp_f32 v20, v20
    v_exp_f32 v21, v21
    v_exp_f32 v22, v22
    v_exp_f32 v23, v23
    v_cvt_pk_bf16_f32 v16, v16, v17
    v_cvt_pk_bf16_f32 v17, v18, v19
    v_cvt_pk_bf16_f32 v18, v20, v21
    v_cvt_pk_bf16_f32 v19, v22, v23
    v_mfma_f32_32x32x16_bf16 v[32:47], v[80:83], v[96:99], 0
    v_exp_f32 v24, v24
    v_exp_f32 v25, v25
    v_exp_f32 v26, v26
    v_exp_f32 v27, v27
    s_waitcnt lgkmcnt(0)
    v_mfma_f32_32x32x16_bf16 v[48:63], v[84:87], v[16:19], v[48:63]
    s_setprio 3
    v_exp_f32 v28, v28
    v_exp_f32 v29, v29
    v_exp_f32 v30, v30
    v_exp_f32 v31, v31
    v_cvt_pk_bf16_f32 v24, v24, v25
    v_cvt_pk_bf16_f32 v25, v26, v27
    v_cvt_pk_bf16_f32 v26, v28, v29
    v_cvt_pk_bf16_f32 v27, v30, v31
    v_exp_f32 v32, v32
    v_exp_f32 v33, v33
    v_mfma_f32_32x32x16_bf16 v[48:63], v[88:91], v[24:27], v[48:63]
    v_exp_f32 v34, v34
    v_exp_f32 v35, v35
    v_exp_f32 v36, v36
    v_exp_f32 v37, v37
    v_exp_f32 v38, v38
    v_exp_f32 v39, v39
    v_cvt_pk_bf16_f32 v32, v32, v33
    v_cvt_pk_bf16_f32 v33, v34, v35
    v_cvt_pk_bf16_f32 v34, v36, v37
    v_cvt_pk_bf16_f32 v35, v38, v39
    v_exp_f32 v40, v40
    v_exp_f32 v41, v41
    v_exp_f32 v42, v42
    v_exp_f32 v43, v43
    v_mfma_f32_32x32x16_bf16 v[64:79], v[84:87], v[32:35], v[64:79]
    s_setprio 2
    v_exp_f32 v44, v44
    v_exp_f32 v45, v45
    v_exp_f32 v46, v46
    v_exp_f32 v47, v47
    v_cvt_pk_bf16_f32 v40, v40, v41
    v_cvt_pk_bf16_f32 v41, v42, v43
    v_cvt_pk_bf16_f32 v42, v44, v45
    v_cvt_pk_bf16_f32 v43, v46, v47
    s_nop 1
    v_mfma_f32_32x32x16_bf16 v[64:79], v[88:91], v[40:43], v[64:79]
    s_setprio 0
    s_nop 10
    v_mov_b32 v71, v64
    ds_write_b128 v182, v[68:71] offset:0
    ds_write_b128 v182, v[72:75] offset:1024
    ds_write_b128 v182, v[76:79] offset:2048
    s_waitcnt vmcnt(0)
    s_waitcnt lgkmcnt(0)
    s_barrier
    ds_read_b128 v[68:71], v183 offset:0
    ds_read_b128 v[72:75], v183 offset:1024
    ds_read_b128 v[76:79], v183 offset:2048
    s_waitcnt lgkmcnt(2)
    v_add_f32 v48, v48, v71
    s_waitcnt lgkmcnt(1)
    v_add_f32 v56, v56, v72
    v_add_f32 v57, v57, v73
    v_add_f32 v58, v58, v74
    v_add_f32 v59, v59, v75
    s_waitcnt lgkmcnt(0)
    v_add_f32 v60, v60, v76
    v_add_f32 v61, v61, v77
    v_add_f32 v62, v62, v78
    v_add_f32 v63, v63, v79
    v_mov_b32 v7, 0x207
    v_cmp_nle_f32 vcc, 0x12800000, v48
    v_cmp_nge_f32 s[16:17], s84, v48
    s_nop 0
    s_or_b64 vcc, vcc, s[16:17]
    v_add_f32 v6, v56, v57
    v_add_f32 v6, v6, v58
    v_add_f32 v6, v6, v59
    v_add_f32 v6, v6, v60
    v_add_f32 v6, v6, v61
    v_add_f32 v6, v6, v62
    v_add_f32 v6, v6, v63
    v_cmp_class_f32 s[16:17], v6, v7
    s_nop 0
    s_or_b64 vcc, vcc, s[16:17]
    s_cmp_lg_u64 vcc, 0
    s_cbranch_scc1 LF_fb
LF_fbr:
    v_rcp_f32 v6, v48
    s_nop 0
    v_mul_f32 v6, v6, v15
    v_mul_f32 v56, v56, v6
    v_mul_f32 v57, v57, v6
    v_mul_f32 v58, v58, v6
    v_mul_f32 v59, v59, v6
    v_mul_f32 v60, v60, v6
    v_mul_f32 v61, v61, v6
    v_mul_f32 v62, v62, v6
    v_mul_f32 v63, v63, v6
    v_cvt_pk_bf16_f32 v64, v56, v57
    v_cvt_pk_bf16_f32 v65, v58, v59
    v_cvt_pk_bf16_f32 v66, v60, v61
    v_cvt_pk_bf16_f32 v67, v62, v63
    v_min_u32 v64, 0xfffffffe, v64
    v_min_u32 v65, 0xfffffffe, v65
    v_min_u32 v66, 0xfffffffe, v66
    v_min_u32 v67, 0xfffffffe, v67
    buffer_store_dwordx4 v[64:67], v3, s[52:55], s9 offen sc1
    s_add_u32 s7, s7, 32768
    v_mov_b32 v6, s93
    s_mov_b64 exec, 1
    buffer_store_dword v6, v9, s[52:55], s7 offen sc1
    s_mov_b64 exec, -1
    s_lshr_b32 s77, s72, 1
    s_lshl_b32 s77, s77, 8
    s_add_u32 s8, s8, s77
    s_add_u32 s8, s8, 32768
    ds_read_b64_tr_b16 v[220:221], v170 offset:16384
    ds_read_b64_tr_b16 v[222:223], v170 offset:17408
    ds_read_b64_tr_b16 v[224:225], v172 offset:16384
    ds_read_b64_tr_b16 v[226:227], v172 offset:17408
    v_mfma_f32_32x32x16_bf16 v[104:119], v[136:139], v[164:167], v[104:119]
    ds_read_b64_tr_b16 v[136:137], v170 offset:24576
    ds_read_b64_tr_b16 v[138:139], v170 offset:25600
    v_mfma_f32_32x32x16_bf16 v[120:135], v[140:143], v[164:167], v[120:135]
    ds_read_b64_tr_b16 v[140:141], v172 offset:24576
    ds_read_b64_tr_b16 v[142:143], v172 offset:25600
    s_waitcnt lgkmcnt(6)
    v_mfma_f32_32x32x16_bf16 v[104:119], v[220:223], v[144:147], v[104:119]
    ds_read_b64_tr_b16 v[220:221], v170 offset:32768
    ds_read_b64_tr_b16 v[222:223], v170 offset:33792
    s_waitcnt lgkmcnt(5)
    v_mfma_f32_32x32x16_bf16 v[120:135], v[224:227], v[144:147], v[120:135]
    ds_read_b64_tr_b16 v[224:225], v172 offset:32768
    ds_read_b64_tr_b16 v[226:227], v172 offset:33792
    s_waitcnt lgkmcnt(4)
    v_mfma_f32_32x32x16_bf16 v[104:119], v[136:139], v[148:151], v[104:119]
    ds_read_b64_tr_b16 v[136:137], v170 offset:40960
    ds_read_b64_tr_b16 v[138:139], v170 offset:41984
    v_mfma_f32_32x32x16_bf16 v[120:135], v[140:143], v[148:151], v[120:135]
    ds_read_b64_tr_b16 v[140:141], v172 offset:40960
    ds_read_b64_tr_b16 v[142:143], v172 offset:41984
    s_waitcnt lgkmcnt(5)
    v_mfma_f32_32x32x16_bf16 v[104:119], v[220:223], v[152:155], v[104:119]
    ds_read_b64_tr_b16 v[48:49], v180 offset:0
    ds_read_b64_tr_b16 v[50:51], v180 offset:1024
    ds_read_b64_tr_b16 v[52:53], v181 offset:0
    ds_read_b64_tr_b16 v[54:55], v181 offset:1024
    ds_read_b64_tr_b16 v[56:57], v180 offset:2048
    ds_read_b64_tr_b16 v[58:59], v180 offset:3072
    ds_read_b64_tr_b16 v[60:61], v181 offset:2048
    ds_read_b64_tr_b16 v[62:63], v181 offset:3072
    s_waitcnt lgkmcnt(8)
    v_mfma_f32_32x32x16_bf16 v[120:135], v[224:227], v[152:155], v[120:135]
    ds_read_b64_tr_b16 v[80:81], v180 offset:4096
    ds_read_b64_tr_b16 v[82:83], v180 offset:5120
    ds_read_b64_tr_b16 v[84:85], v181 offset:4096
    ds_read_b64_tr_b16 v[86:87], v181 offset:5120
    ds_read_b64_tr_b16 v[88:89], v180 offset:6144
    ds_read_b64_tr_b16 v[90:91], v180 offset:7168
    ds_read_b64_tr_b16 v[92:93], v181 offset:6144
    ds_read_b64_tr_b16 v[94:95], v181 offset:7168
    v_mfma_f32_32x32x16_bf16 v[104:119], v[136:139], v[156:159], v[104:119]
    ds_read_b64_tr_b16 v[188:189], v180 offset:8192
    ds_read_b64_tr_b16 v[190:191], v180 offset:9216
    ds_read_b64_tr_b16 v[192:193], v181 offset:8192
    ds_read_b64_tr_b16 v[194:195], v181 offset:9216
    ds_read_b64_tr_b16 v[196:197], v180 offset:10240
    ds_read_b64_tr_b16 v[198:199], v180 offset:11264
    ds_read_b64_tr_b16 v[200:201], v181 offset:10240
    ds_read_b64_tr_b16 v[202:203], v181 offset:11264
    v_mfma_f32_32x32x16_bf16 v[120:135], v[140:143], v[156:159], v[120:135]
    ds_read_b64_tr_b16 v[204:205], v180 offset:12288
    ds_read_b64_tr_b16 v[206:207], v180 offset:13312
    ds_read_b64_tr_b16 v[208:209], v181 offset:12288
    ds_read_b64_tr_b16 v[210:211], v181 offset:13312
    ds_read_b64_tr_b16 v[212:213], v180 offset:14336
    ds_read_b64_tr_b16 v[214:215], v180 offset:15360
    ds_read_b64_tr_b16 v[216:217], v181 offset:14336
    ds_read_b64_tr_b16 v[218:219], v181 offset:15360
    s_mov_b64 exec, 0xffff
    buffer_load_dword v178, v174, s[52:55], s8 offen sc1
    s_mov_b64 exec, -1
    s_waitcnt lgkmcnt(0)
    s_barrier
    s_mov_b64 exec, 0xffff
    s_waitcnt vmcnt(0)
    v_cmp_ne_u32 vcc, s93, v178
    s_mov_b64 exec, -1
    s_cbranch_vccz LR5
    s_mov_b32 s90, 0
LS5_l:
    s_sleep 1
    s_mov_b64 exec, 0xffff
    buffer_load_dword v178, v174, s[52:55], s8 offen sc1
    s_mov_b64 exec, -1
    s_waitcnt vmcnt(0)
    s_mov_b64 exec, 0xffff
    v_cmp_ne_u32 vcc, s93, v178
    s_mov_b64 exec, -1
    s_add_u32 s90, s90, 1
    s_cmp_ge_u32 s90, 0x400000
    s_cbranch_scc1 LR5
    s_cbranch_vccnz LS5_l
LR5:
    buffer_load_dwordx4 v[16:19], v3, s[52:55], s10 offen offset:0 sc1
    buffer_load_dwordx4 v[20:23], v3, s[52:55], s10 offen offset:1024 sc1
    buffer_load_dwordx4 v[24:27], v3, s[52:55], s10 offen offset:2048 sc1
    buffer_load_dwordx4 v[28:31], v3, s[52:55], s10 offen offset:3072 sc1
    buffer_load_dwordx4 v[32:35], v3, s[52:55], s18 offen offset:0 sc1
    buffer_load_dwordx4 v[36:39], v3, s[52:55], s18 offen offset:1024 sc1
    buffer_load_dwordx4 v[40:43], v3, s[52:55], s18 offen offset:2048 sc1
    buffer_load_dwordx4 v[44:47], v3, s[52:55], s18 offen offset:3072 sc1
    v_sub_f32 v7, 1.0, v15
    v_mov_b32 v6, v7
    v_pk_mul_f32 v[104:105], v[104:105], v[6:7]
    v_pk_mul_f32 v[106:107], v[106:107], v[6:7]
    v_pk_mul_f32 v[108:109], v[108:109], v[6:7]
    v_pk_mul_f32 v[110:111], v[110:111], v[6:7]
    v_pk_mul_f32 v[112:113], v[112:113], v[6:7]
    v_pk_mul_f32 v[114:115], v[114:115], v[6:7]
    v_pk_mul_f32 v[116:117], v[116:117], v[6:7]
    v_pk_mul_f32 v[118:119], v[118:119], v[6:7]
    v_pk_mul_f32 v[120:121], v[120:121], v[6:7]
    v_pk_mul_f32 v[122:123], v[122:123], v[6:7]
    v_pk_mul_f32 v[124:125], v[124:125], v[6:7]
    v_pk_mul_f32 v[126:127], v[126:127], v[6:7]
    v_pk_mul_f32 v[128:129], v[128:129], v[6:7]
    v_pk_mul_f32 v[130:131], v[130:131], v[6:7]
    v_pk_mul_f32 v[132:133], v[132:133], v[6:7]
    v_pk_mul_f32 v[134:135], v[134:135], v[6:7]
    s_waitcnt vmcnt(7)
    v_max3_u32 v6, v16, v17, v18
    s_waitcnt vmcnt(6)
    v_max3_u32 v6, v19, v20, v6
    v_max3_u32 v6, v21, v22, v6
    s_waitcnt vmcnt(5)
    v_max3_u32 v6, v23, v24, v6
    v_max3_u32 v6, v25, v26, v6
    s_waitcnt vmcnt(4)
    v_max3_u32 v6, v27, v28, v6
    v_max3_u32 v6, v29, v30, v6
    v_max_u32 v6, v31, v6
    v_cmp_eq_u32 vcc, -1, v6
    s_cbranch_vccz LR6
    s_mov_b32 s90, 0
LS6_p:
    s_sleep 1
    s_mov_b64 exec, 0xf
    buffer_load_dword v178, v179, s[52:55], s10 offen offset:1020 sc1
    s_waitcnt vmcnt(0)
    v_cmp_eq_u32 vcc, -1, v178
    s_mov_b64 exec, -1
    s_add_u32 s90, s90, 1
    s_cmp_ge_u32 s90, 0x400000
    s_cbranch_scc1 LR6
    s_cbranch_vccnz LS6_p
    buffer_load_dwordx4 v[16:19], v3, s[52:55], s10 offen offset:0 sc1
    buffer_load_dwordx4 v[20:23], v3, s[52:55], s10 offen offset:1024 sc1
    buffer_load_dwordx4 v[24:27], v3, s[52:55], s10 offen offset:2048 sc1
    buffer_load_dwordx4 v[28:31], v3, s[52:55], s10 offen offset:3072 sc1
    s_waitcnt vmcnt(0)
    v_max3_u32 v6, v16, v17, v18
    v_max3_u32 v6, v19, v20, v6
    v_max3_u32 v6, v21, v22, v6
    v_max3_u32 v6, v23, v24, v6
    v_max3_u32 v6, v25, v26, v6
    v_max3_u32 v6, v27, v28, v6
    v_max3_u32 v6, v29, v30, v6
    v_max_u32 v6, v31, v6
    v_cmp_eq_u32 vcc, -1, v6
    s_cbranch_vccnz LS6_p
LR6:
    v_mfma_f32_32x32x16_bf16 v[120:135], v[52:55], v[16:19], v[120:135]
    v_mfma_f32_32x32x16_bf16 v[120:135], v[60:63], v[20:23], v[120:135]
    v_mfma_f32_32x32x16_bf16 v[120:135], v[84:87], v[24:27], v[120:135]
    v_mfma_f32_32x32x16_bf16 v[120:135], v[92:95], v[28:31], v[120:135]
    s_waitcnt vmcnt(3)
    v_max3_u32 v6, v32, v33, v34
    s_waitcnt vmcnt(2)
    v_max3_u32 v6, v35, v36, v6
    v_max3_u32 v6, v37, v38, v6
    s_waitcnt vmcnt(1)
    v_max3_u32 v6, v39, v40, v6
    v_max3_u32 v6, v41, v42, v6
    s_waitcnt vmcnt(0)
    v_max3_u32 v6, v43, v44, v6
    v_max3_u32 v6, v45, v46, v6
    v_max_u32 v6, v47, v6
    v_cmp_eq_u32 vcc, -1, v6
    s_cbranch_vccz LR7
    s_mov_b32 s90, 0
LS7_p:
    s_sleep 1
    s_mov_b64 exec, 0xf
    buffer_load_dword v178, v179, s[52:55], s18 offen offset:1020 sc1
    s_waitcnt vmcnt(0)
    v_cmp_eq_u32 vcc, -1, v178
    s_mov_b64 exec, -1
    s_add_u32 s90, s90, 1
    s_cmp_ge_u32 s90, 0x400000
    s_cbranch_scc1 LR7
    s_cbranch_vccnz LS7_p
    buffer_load_dwordx4 v[32:35], v3, s[52:55], s18 offen offset:0 sc1
    buffer_load_dwordx4 v[36:39], v3, s[52:55], s18 offen offset:1024 sc1
    buffer_load_dwordx4 v[40:43], v3, s[52:55], s18 offen offset:2048 sc1
    buffer_load_dwordx4 v[44:47], v3, s[52:55], s18 offen offset:3072 sc1
    s_waitcnt vmcnt(0)
    v_max3_u32 v6, v32, v33, v34
    v_max3_u32 v6, v35, v36, v6
    v_max3_u32 v6, v37, v38, v6
    v_max3_u32 v6, v39, v40, v6
    v_max3_u32 v6, v41, v42, v6
    v_max3_u32 v6, v43, v44, v6
    v_max3_u32 v6, v45, v46, v6
    v_max_u32 v6, v47, v6
    v_cmp_eq_u32 vcc, -1, v6
    s_cbranch_vccnz LS7_p
LR7:
    v_mfma_f32_32x32x16_bf16 v[120:135], v[192:195], v[32:35], v[120:135]
    v_mfma_f32_32x32x16_bf16 v[120:135], v[200:203], v[36:39], v[120:135]
    v_mfma_f32_32x32x16_bf16 v[120:135], v[208:211], v[40:43], v[120:135]
    v_mfma_f32_32x32x16_bf16 v[120:135], v[216:219], v[44:47], v[120:135]
    v_mfma_f32_32x32x16_bf16 v[104:119], v[48:51], v[16:19], v[104:119]
    v_mfma_f32_32x32x16_bf16 v[104:119], v[56:59], v[20:23], v[104:119]
    v_mfma_f32_32x32x16_bf16 v[104:119], v[80:83], v[24:27], v[104:119]
    v_mfma_f32_32x32x16_bf16 v[104:119], v[88:91], v[28:31], v[104:119]
    s_nop 7
    ds_write_b128 v169, v[120:123] offset:2048
    v_mfma_f32_32x32x16_bf16 v[104:119], v[188:191], v[32:35], v[104:119]
    ds_write_b128 v169, v[124:127] offset:3072
    v_mfma_f32_32x32x16_bf16 v[104:119], v[196:199], v[36:39], v[104:119]
    ds_write_b128 v175, v[128:131] offset:4096
    v_mfma_f32_32x32x16_bf16 v[104:119], v[204:207], v[40:43], v[104:119]
    ds_write_b128 v175, v[132:135] offset:5120
    v_mfma_f32_32x32x16_bf16 v[104:119], v[212:215], v[44:47], v[104:119]
    s_nop 11
    ds_write_b128 v168, v[112:115] offset:0
    ds_write_b128 v168, v[116:119] offset:1024
    s_waitcnt lgkmcnt(0)
    s_barrier
    ds_read_b128 v[16:19], v176 offset:0
    ds_read_b128 v[20:23], v176 offset:1024
    ds_read_b128 v[24:27], v176 offset:2048
    ds_read_b128 v[28:31], v176 offset:3072
    ds_read_b128 v[32:35], v176 offset:4096
    ds_read_b128 v[36:39], v176 offset:5120
    s_waitcnt lgkmcnt(5)
    v_add_f32 v104, v104, v16
    v_add_f32 v105, v105, v17
    v_add_f32 v106, v106, v18
    v_add_f32 v107, v107, v19
    s_waitcnt lgkmcnt(3)
    v_add_f32 v108, v108, v20
    v_add_f32 v109, v109, v21
    v_add_f32 v110, v110, v22
    v_add_f32 v111, v111, v23
    v_add_f32 v104, v104, v24
    v_add_f32 v105, v105, v25
    v_add_f32 v106, v106, v26
    v_add_f32 v107, v107, v27
    s_waitcnt lgkmcnt(0)
    v_add_f32 v108, v108, v28
    v_add_f32 v109, v109, v29
    v_add_f32 v110, v110, v30
    v_add_f32 v111, v111, v31
    v_add_f32 v104, v104, v32
    v_add_f32 v105, v105, v33
    v_add_f32 v106, v106, v34
    v_add_f32 v107, v107, v35
    v_add_f32 v108, v108, v36
    v_add_f32 v109, v109, v37
    v_add_f32 v110, v110, v38
    v_add_f32 v111, v111, v39
    v_cvt_pk_bf16_f32 v120, v104, v105
    v_cvt_pk_bf16_f32 v121, v106, v107
    v_cvt_pk_bf16_f32 v122, v108, v109
    v_cvt_pk_bf16_f32 v123, v110, v111
    s_nop 0
    v_permlane32_swap_b32 v120, v122
    v_permlane32_swap_b32 v121, v123
    buffer_store_dwordx4 v[120:123], v177, s[56:59], s11 offen
LF_end:
    s_endpgm
LF_fb:
    s_waitcnt vmcnt(0) lgkmcnt(0)
    v_mov_b32 v6, 0xff800000
    s_mov_b32 s76, 0x0
LF_fb1:
    buffer_load_dwordx4 v[80:83], v3, s[52:55], s76 offen sc1
    s_waitcnt vmcnt(0)
    v_mfma_f32_32x32x16_bf16 v[16:31], v[80:83], v[92:95], 0
    s_nop 15
    v_max3_f32 v6, v16, v17, v6
    v_max3_f32 v6, v18, v19, v6
    v_max3_f32 v6, v20, v21, v6
    v_max3_f32 v6, v22, v23, v6
    v_max3_f32 v6, v24, v25, v6
    v_max3_f32 v6, v26, v27, v6
    v_max3_f32 v6, v28, v29, v6
    v_max3_f32 v6, v30, v31, v6
    s_add_u32 s76, s76, 1024
    s_cmp_lt_u32 s76, 0x10000
    s_cbranch_scc1 LF_fb1
    v_mov_b32 v7, v6
    s_nop 1
    v_permlane32_swap_b32 v6, v7
    s_nop 1
    v_max_f32 v6, v6, v7
    v_sub_f32 v64, 0, v6
    v_sub_f32 v65, 0, v6
    v_sub_f32 v66, 0, v6
    v_sub_f32 v67, 0, v6
    v_sub_f32 v68, 0, v6
    v_sub_f32 v69, 0, v6
    v_sub_f32 v70, 0, v6
    v_sub_f32 v71, 0, v6
    v_sub_f32 v72, 0, v6
    v_sub_f32 v73, 0, v6
    v_sub_f32 v74, 0, v6
    v_sub_f32 v75, 0, v6
    v_sub_f32 v76, 0, v6
    v_sub_f32 v77, 0, v6
    v_sub_f32 v78, 0, v6
    v_sub_f32 v79, 0, v6
    v_mov_b32 v48, 0
    v_mov_b32 v49, 0
    v_mov_b32 v50, 0
    v_mov_b32 v51, 0
    v_mov_b32 v52, 0
    v_mov_b32 v53, 0
    v_mov_b32 v54, 0
    v_mov_b32 v55, 0
    v_mov_b32 v56, 0
    v_mov_b32 v57, 0
    v_mov_b32 v58, 0
    v_mov_b32 v59, 0
    v_mov_b32 v60, 0
    v_mov_b32 v61, 0
    v_mov_b32 v62, 0
    v_mov_b32 v63, 0
    v_lshrrev_b32 v6, 5, v2
    v_lshlrev_b32 v6, 8, v6
    v_and_b32 v7, 15, v2
    v_lshl_add_u32 v6, v7, 4, v6
    v_and_b32 v7, 16, v2
    v_cmp_eq_u32 vcc, 0, v7
    v_mov_b32 v7, 0x40000000
    s_nop 1
    v_cndmask_b32 v6, v6, v7, vcc
    v_and_b32 v7, 27, v2
    v_cmp_eq_u32 vcc, 0, v7
    v_mov_b32 v184, 0x3f803f80
    s_nop 1
    v_cndmask_b32 v184, 0, v184, vcc
    s_mov_b32 s76, 0x0
LF_fb2:
    s_add_u32 s77, s76, 0x10000
    buffer_load_dwordx4 v[80:83], v3, s[52:55], s76 offen sc1
    buffer_load_dwordx4 v[84:87], v6, s[52:55], s77 offen sc1
    buffer_load_dwordx4 v[88:91], v6, s[52:55], s77 offen offset:512 sc1
    s_waitcnt vmcnt(0)
    v_mfma_f32_32x32x16_bf16 v[16:31], v[80:83], v[92:95], v[64:79]
    v_or_b32 v84, v84, v184
    v_or_b32 v85, v85, v184
    v_or_b32 v86, v86, v184
    v_or_b32 v87, v87, v184
    v_or_b32 v88, v88, v184
    v_or_b32 v89, v89, v184
    v_or_b32 v90, v90, v184
    v_or_b32 v91, v91, v184
    s_nop 7
    v_exp_f32 v16, v16
    v_exp_f32 v17, v17
    v_exp_f32 v18, v18
    v_exp_f32 v19, v19
    v_exp_f32 v20, v20
    v_exp_f32 v21, v21
    v_exp_f32 v22, v22
    v_exp_f32 v23, v23
    v_exp_f32 v24, v24
    v_exp_f32 v25, v25
    v_exp_f32 v26, v26
    v_exp_f32 v27, v27
    v_exp_f32 v28, v28
    v_exp_f32 v29, v29
    v_exp_f32 v30, v30
    v_exp_f32 v31, v31
    s_nop 1
    v_cvt_pk_bf16_f32 v32, v16, v17
    v_cvt_pk_bf16_f32 v33, v18, v19
    v_cvt_pk_bf16_f32 v34, v20, v21
    v_cvt_pk_bf16_f32 v35, v22, v23
    v_cvt_pk_bf16_f32 v36, v24, v25
    v_cvt_pk_bf16_f32 v37, v26, v27
    v_cvt_pk_bf16_f32 v38, v28, v29
    v_cvt_pk_bf16_f32 v39, v30, v31
    s_nop 1
    v_mfma_f32_32x32x16_bf16 v[48:63], v[84:87], v[32:35], v[48:63]
    v_mfma_f32_32x32x16_bf16 v[48:63], v[88:91], v[36:39], v[48:63]
    s_add_u32 s76, s76, 1024
    s_cmp_lt_u32 s76, 0x10000
    s_cbranch_scc1 LF_fb2
    s_nop 15
    s_branch LF_fbr
LF_last:
    s_endpgm
.section .rodata,"a"
.p2align 6
.amdhsa_kernel gated_mix__grouped_kv_mqa__glu_gated_geglu__prompt_kernel
  .amdhsa_next_free_vgpr 249
  .amdhsa_next_free_sgpr 96
  .amdhsa_accum_offset 252
  .amdhsa_group_segment_fixed_size 0
  .amdhsa_kernarg_size 104
  .amdhsa_user_sgpr_count 2
  .amdhsa_user_sgpr_kernarg_segment_ptr 1
  .amdhsa_system_sgpr_workgroup_id_x 1
.end_amdhsa_kernel
```
